```python
import torch

def _softmax(x, axis=-1):
    return torch.softmax(x, dim=axis)
def _gelu(x):
    return torch.nn.functional.gelu(x, approximate="tanh")
def _silu(x):
    return torch.nn.functional.silu(x)
def _sigmoid(x):
    return torch.sigmoid(x)
def _layernorm(x, axis=-1, eps=1e-5):
    m = x.mean(dim=axis, keepdim=True)
    v = x.var(dim=axis, keepdim=True, unbiased=False)
    return (x - m) / torch.sqrt(v + eps)
def _scatter_add(tgt, idx, src, axis=0):
    return tgt.clone().index_add_(axis, idx, src)
def _segment_sum(src, seg, n):
    out = torch.zeros((n,) + src.shape[1:], dtype=src.dtype)
    return out.index_add_(0, seg, src)
def _pad(x, pw):
    flat = tuple(v for pair in reversed(pw) for v in pair)
    return torch.nn.functional.pad(x, flat)

kernel_name = 'gated_mix__ssm_conv_s4__glu_gated_swiglu__prompt'

def setup_inputs():

    _w = (lambda a: (lambda t: t.to(torch.bfloat16) if t.is_floating_point() else t)(torch.as_tensor(a)))
    def _A_setup():
        B, L, D, N = 1, 2048, 512, 128
        A_re = -(lambda _x: torch.exp(torch.as_tensor(_x)))((lambda *s: torch.randn(*s, dtype=torch.bfloat16) * 3.2)(D, N))
        A_im = torch.pi * (lambda *s: torch.randn(*s, dtype=torch.bfloat16) * 0.05)(D, N)
        B_re = (lambda *s: torch.randn(*s, dtype=torch.bfloat16) * 0.1)(D, N)
        B_im = (lambda *s: torch.randn(*s, dtype=torch.bfloat16) * 0.1)(D, N)
        C_re = (lambda *s: torch.randn(*s, dtype=torch.bfloat16) * 0.1)(D, N)
        C_im = (lambda *s: torch.randn(*s, dtype=torch.bfloat16) * 0.1)(D, N)
        log_dt = (lambda *s: torch.randn(*s, dtype=torch.bfloat16) * 0.05)(D) * 0.5 - 4.0
        Dskip = (lambda *s: torch.randn(*s, dtype=torch.bfloat16) * 0.05)(D)
        return {
            "u": _w((lambda *s: torch.randn(*s, dtype=torch.bfloat16) * 0.05)(B, L, D)),
            "A_re": _w(A_re),
            "A_im": _w(A_im),
            "B_re": _w(B_re),
            "B_im": _w(B_im),
            "C_re": _w(C_re),
            "C_im": _w(C_im),
            "log_dt": _w(log_dt),
            "Dskip": _w(Dskip),
        }
    _A_in = _A_setup()

    def _B_setup():
        B, S, D, F = 1, 2048, 512, 1792
        return {
            "x": _w((lambda *s: torch.randn(*s, dtype=torch.bfloat16) * 0.05)(B, S, D)),
            "w1": _w((lambda *s: torch.randn(*s, dtype=torch.bfloat16) * 0.8)(D, F) * (2.0 / D) ** 0.5),
            "w3": _w((lambda *s: torch.randn(*s, dtype=torch.bfloat16) * 0.8)(D, F) * (2.0 / D) ** 0.5),
            "w2": _w((lambda *s: torch.randn(*s, dtype=torch.bfloat16) * 0.8)(F, D) * (2.0 / F) ** 0.5),
        }
    _B_in = _B_setup()

    return {
        "A_u": _A_in["u"],
        "A_A_re": _A_in["A_re"],
        "A_A_im": _A_in["A_im"],
        "A_B_re": _A_in["B_re"],
        "A_B_im": _A_in["B_im"],
        "A_C_re": _A_in["C_re"],
        "A_C_im": _A_in["C_im"],
        "A_log_dt": _A_in["log_dt"],
        "A_Dskip": _A_in["Dskip"],
        "B_x": _B_in["x"],
        "B_w1": _B_in["w1"],
        "B_w3": _B_in["w3"],
        "B_w2": _B_in["w2"],
        "gate_w": _w((lambda *s: torch.randn(*s, dtype=torch.bfloat16) * 0.05)(512) * 16.0),
    }

def reference(A_u, A_A_re, A_A_im, A_B_re, A_B_im, A_C_re, A_C_im, A_log_dt, A_Dskip, B_x, B_w1, B_w3, B_w2, gate_w):
    def _A_ref(u, A_re, A_im, B_re, B_im, C_re, C_im, log_dt, Dskip):
        Bsz, L, D = u.shape
        dt = torch.exp(log_dt)[:, None]
        A = A_re + 1j * A_im
        Bc = B_re + 1j * B_im
        Cc = C_re + 1j * C_im
        logdA = dt * A
        dB = dt * Bc
        l = (lambda x, dt: x.to(dt))(torch.arange(L), A_re.dtype)
        P = torch.exp(logdA[:, :, None] * l[None, None, :])
        K = torch.einsum("dn,dnl,dn->dl", Cc, P, dB).real
        L2 = 2 * L
        Kp = _pad(K, ((0, 0), (0, L)))
        up = (lambda x, *d: x.permute(*d))(u, 0, 2, 1)
        up = _pad(up, ((0, 0), (0, 0), (0, L)))
        Kf = (lambda x, axes=(-2,-1): torch.fft.rfft2(x.float(), dim=axes))(Kp[:, None, :], axes=(-2, -1))
        Uf = (lambda x, axes=(-2,-1): torch.fft.rfft2(x.float(), dim=axes))(up[:, :, None, :], axes=(-2, -1))
        Yf = Uf * Kf[None, :, :, :]
        y = (lambda x, s, axes=(-2,-1): torch.fft.irfft2(x, s=s, dim=axes).to(torch.bfloat16))(Yf, (1, L2), axes=(-2, -1))[:, :, 0, :L]
        y = (lambda x, *d: x.permute(*d))(y, 0, 2, 1) + u * Dskip[None, None, :]
        return y

    def _B_ref(x, w1, w3, w2):
        gate = torch.einsum("bsd,df->bsf", x, w1)
        up = torch.einsum("bsd,df->bsf", x, w3)
        h = _silu(gate) * up
        out = torch.einsum("bsf,fd->bsd", h, w2)
        return out

    x = A_u
    g = _sigmoid((x * gate_w).sum(-1, keepdims=True))
    a = _A_ref(x, A_A_re, A_A_im, A_B_re, A_B_im, A_C_re, A_C_im, A_log_dt, A_Dskip)
    b = _B_ref(x, B_w1, B_w3, B_w2)
    return g * a + (1 - g) * b
```

```asm
; @launch grid=(256,1,1) block=(512,1,1) lds=163840
.amdgcn_target "amdgcn-amd-amdhsa--gfx950"
.text
.globl gated_mix__ssm_conv_s4__glu_gated_swiglu__prompt_kernel
.p2align 8
.type gated_mix__ssm_conv_s4__glu_gated_swiglu__prompt_kernel,@function
gated_mix__ssm_conv_s4__glu_gated_swiglu__prompt_kernel:
    s_cmp_ge_u32 s2, 256
    s_cbranch_scc1 L_end
    s_load_dwordx16 s[4:19], s[0:1], 0
    s_load_dwordx16 s[20:35], s[0:1], 64
    s_load_dwordx2 s[36:37], s[0:1], 128
    v_and_b32 v1, 63, v0
    v_lshrrev_b32 v2, 6, v0
    s_getpc_b64 s[90:91]
    s_and_b32 s90, s90, 0xffffff00
    s_lshr_b32 s64, s2, 3
    s_lshl_b32 s64, s64, 4
    v_and_b32 v4, 1, v0
    v_lshl_add_u32 v4, v2, 1, v4
    v_add_u32 v4, s64, v4
    v_min_u32 v4, 257, v4
    v_lshlrev_b32 v4, 7, v4
    global_load_dword v253, v4, s[90:91]
    v_readfirstlane_b32 s38, v2
    s_and_b32 s39, s2, 7
    s_lshr_b32 s40, s2, 3
    s_and_b32 s45, s38, 3
    s_lshr_b32 s84, s45, 1
    s_and_b32 s85, s45, 1
    s_lshl_b32 s86, s2, 1
    s_add_u32 s86, s86, s84
    s_max_u32 s65, s40, 4
    s_sub_u32 s65, s65, 4
    s_mul_i32 s41, s65, 37
    s_lshr_b32 s41, s41, 8
    s_mul_i32 s64, s41, 7
    s_sub_u32 s42, s65, s64
    s_lshr_b32 s64, s39, 1
    s_lshl_b32 s64, s64, 2
    s_add_u32 s41, s41, s64
    s_and_b32 s64, s39, 1
    s_mul_i32 s64, s64, 7
    s_add_u32 s42, s42, s64
    s_lshl_b32 s43, s39, 2
    s_lshr_b32 s64, s40, 3
    s_add_u32 s43, s43, s64
    s_and_b32 s44, s40, 7
    s_mul_i32 s80, s45, 8704
    s_add_u32 s80, s80, 1024
    s_waitcnt lgkmcnt(0)
    s_lshl_b32 s69, s86, 8
    s_lshl_b32 s70, s85, 7
    s_add_u32 s69, s69, s70
    v_lshlrev_b32 v240, 1, v1
    v_add_u32 v240, s69, v240
    v_mov_b32 v232, 0
    v_mov_b32 v233, 0
    v_mov_b32 v234, 0
    v_mov_b32 v235, 0
    v_mov_b32 v236, 0
    v_mov_b32 v237, 0
    v_mov_b32 v238, 0
    v_mov_b32 v239, 0
    global_load_short_d16_hi v232, v240, s[6:7]
    global_load_short_d16_hi v233, v240, s[8:9]
    global_load_short_d16_hi v234, v240, s[10:11]
    global_load_short_d16_hi v235, v240, s[12:13]
    global_load_short_d16_hi v236, v240, s[14:15]
    global_load_short_d16_hi v237, v240, s[16:17]
    s_lshl_b32 s70, s86, 1
    v_mov_b32 v241, s70
    global_load_short_d16_hi v238, v241, s[18:19]
    global_load_short_d16_hi v239, v241, s[20:21]
    s_barrier
    s_cmp_ge_u32 s38, 4
    s_cbranch_scc1 L_H
    s_mov_b32 s60, s36
    s_mov_b32 s61, s37
    s_mov_b32 s62, 0xe00000
    s_mov_b32 s63, 0x20000
    s_mov_b32 s52, s28
    s_mov_b32 s53, s29
    s_mov_b32 s54, 0x1c0000
    s_mov_b32 s55, 0x20000
    v_lshrrev_b32 v4, 3, v1
    v_lshlrev_b32 v2, 10, v4
    v_and_b32 v4, 2, v4
    v_bfe_u32 v5, v1, 1, 2
    v_xor_b32 v4, v4, v5
    v_lshl_add_u32 v2, v4, 5, v2
    v_and_b32 v4, 1, v1
    v_lshl_add_u32 v2, v4, 4, v2
    s_lshl_b32 s64, s44, 7
    s_mul_i32 s65, s45, 458752
    s_add_u32 s64, s64, s65
    v_add_u32 v2, s64, v2
    s_mul_i32 s66, s45, 6144
    s_add_u32 s66, s66, 65536
    s_mov_b32 s56, s32
    s_mov_b32 s57, s33
    s_mov_b32 s58, 0x200000
    s_mov_b32 s59, 0x20000
    v_bfe_u32 v4, v1, 2, 2
    v_lshrrev_b32 v5, 5, v1
    v_lshl_add_u32 v5, v5, 2, v4
    v_lshlrev_b32 v6, 7, v5
    v_and_b32 v4, 2, v4
    v_bfe_u32 v5, v1, 4, 1
    v_xor_b32 v4, v4, v5
    v_lshl_add_u32 v6, v4, 5, v6
    v_and_b32 v4, 3, v1
    v_lshl_add_u32 v6, v4, 3, v6
    s_lshl_b32 s64, s84, 6
    v_xor_b32 v6, s64, v6
    v_xor_b32 v7, 64, v6
    v_add_u32 v6, s66, v6
    v_add_u32 v7, s66, v7
    v_lshlrev_b32 v8, 4, v1
    s_cmp_lt_u32 s40, 4
    s_cbranch_scc1 L_Maux
    v_bfe_u32 v22, v1, 4, 1
    v_lshrrev_b32 v23, 5, v1
    v_bfe_u32 v24, v1, 2, 2
    v_lshlrev_b32 v25, 13, v22
    v_lshl_add_u32 v25, v23, 11, v25
    v_lshl_add_u32 v25, v24, 8, v25
    v_lshl_add_u32 v26, v22, 2, v24
    v_lshl_add_u32 v25, v26, 5, v25
    v_and_b32 v26, 3, v1
    v_lshl_add_u32 v25, v26, 3, v25
    s_lshl_b32 s78, s85, 7
    v_xor_b32 v25, s78, v25
    v_add_u32 v25, 40960, v25
    v_xor_b32 v10, 0, v25
    v_add_u32 v14, 73728, v10
    v_xor_b32 v11, 32, v25
    v_add_u32 v15, 73728, v11
    v_xor_b32 v12, 64, v25
    v_add_u32 v16, 73728, v12
    v_xor_b32 v13, 96, v25
    v_add_u32 v17, 73728, v13
    v_and_b32 v25, 31, v1
    v_bfe_u32 v26, v1, 2, 2
    v_xor_b32 v26, v26, v23
    v_lshlrev_b32 v25, 6, v25
    v_lshl_add_u32 v25, v26, 4, v25
    s_lshl_b32 s78, s84, 12
    s_add_u32 s78, s78, 57344
    v_xor_b32 v19, 32, v25
    v_add_u32 v18, s78, v25
    v_add_u32 v19, s78, v19
    v_add_u32 v20, 73728, v18
    v_add_u32 v21, 73728, v19
    v_subrev_u32 v22, 39936, v10
    v_subrev_u32 v23, 39936, v11
    v_subrev_u32 v24, 39936, v12
    v_subrev_u32 v25, 39936, v13
    v_subrev_u32 v26, 39936, v18
    v_subrev_u32 v27, 39936, v19
    s_lshl_b32 s78, s41, 2
    s_lshl_b32 s79, s84, 1
    s_add_u32 s78, s78, s79
    s_mul_i32 s78, s78, 112
    s_lshl_b32 s79, s42, 3
    s_add_u32 s78, s78, s79
    s_lshl_b32 s79, s85, 2
    s_add_u32 s78, s78, s79
    s_lshl_b32 s78, s78, 10
    s_add_u32 s79, s78, 114688
    s_lshl_b32 s81, s41, 1
    s_add_u32 s81, s81, s84
    s_lshl_b32 s81, s81, 5
    s_lshl_b32 s82, s42, 1
    s_add_u32 s81, s81, s82
    s_add_u32 s81, s81, s85
    s_lshl_b32 s81, s81, 7
    s_add_u32 s81, s81, 12648448
    s_lshl_b32 s70, s45, 2
    s_add_u32 s70, s70, 64
    v_mov_b32 v28, s70
    v_mov_b32 v29, 1
    v_mov_b32 v30, 80
    s_waitcnt vmcnt(0)
L_kgen:
    v_and_b32 v243, 15, v1
    v_lshrrev_b32 v244, 4, v1
    v_mul_u32_u24 v242, 272, v243
    v_lshl_add_u32 v242, v244, 4, v242
    v_add_u32 v242, s80, v242
    s_mov_b32 m0, s80
    s_mov_b32 s76, 0x3fb8aa3b
    s_mov_b32 s77, 0x32a57060
    v_mul_f32 v243, s76, v238
    v_fma_f32 v244, v238, s76, -v243
    v_fma_f32 v244, v238, s77, v244
    v_exp_f32 v243, v243
    v_mul_f32 v244, 0x3f317218, v244
    v_fma_f32 v243, v243, v244, v243
    v_cvt_pk_bf16_f32 v243, v243, v243
    v_and_b32 v243, 0xffff0000, v243
    v_mul_f32 v232, v243, v232
    v_mul_f32 v233, v243, v233
    v_mul_f32 v234, v243, v234
    v_mul_f32 v235, v243, v235
    v_mul_f32 v232, s76, v232
    v_mul_f32 v233, 0.15915494, v233
    v_mul_f32 v180, 0x41000000, v232
    v_mul_f32 v181, 0x41000000, v233
    v_mul_f32 v182, 0x43000000, v232
    v_mul_f32 v183, 0x43000000, v233
    v_mul_f32 v184, 0x40800000, v232
    v_mul_f32 v185, 0x40800000, v233
    v_mul_f32 v186, 0x42000000, v232
    v_mul_f32 v187, 0x42000000, v233
    v_mul_f32 v188, 0x3f800000, v232
    v_mul_f32 v189, 0x3f800000, v233
    v_mul_f32 v190, 0x44000000, v232
    v_mul_f32 v191, 0x44000000, v233
    v_exp_f32 v180, v180
    v_fract_f32 v181, v181
    v_exp_f32 v182, v182
    v_fract_f32 v183, v183
    v_exp_f32 v184, v184
    v_fract_f32 v185, v185
    v_exp_f32 v186, v186
    v_fract_f32 v187, v187
    v_exp_f32 v188, v188
    v_fract_f32 v189, v189
    v_exp_f32 v190, v190
    v_fract_f32 v191, v191
    v_cos_f32 v46, v181
    v_sin_f32 v47, v181
    v_cos_f32 v48, v183
    v_sin_f32 v49, v183
    v_cos_f32 v38, v185
    v_sin_f32 v39, v185
    v_cos_f32 v52, v187
    v_sin_f32 v53, v187
    v_cos_f32 v32, v189
    v_sin_f32 v33, v189
    v_cos_f32 v50, v191
    v_sin_f32 v51, v191
    s_nop 0
    v_mul_f32 v46, v180, v46
    v_mul_f32 v47, v180, v47
    v_mul_f32 v48, v182, v48
    v_mul_f32 v49, v182, v49
    v_mul_f32 v38, v184, v38
    v_mul_f32 v39, v184, v39
    v_mul_f32 v52, v186, v52
    v_mul_f32 v53, v186, v53
    v_mul_f32 v32, v188, v32
    v_mul_f32 v33, v188, v33
    v_mul_f32 v50, v190, v50
    v_mul_f32 v51, v190, v51
    v_pk_mul_f32 v[120:121], v[236:237], v[234:235] op_sel:[0,0] op_sel_hi:[0,1]
    v_pk_mul_f32 v[200:201], v[46:47], v[46:47] op_sel:[0,0] op_sel_hi:[0,1]
    v_pk_mul_f32 v[54:55], v[48:49], v[48:49] op_sel:[0,0] op_sel_hi:[0,1]
    v_pk_mul_f32 v[206:207], v[46:47], v[52:53] op_sel:[0,0] op_sel_hi:[0,1]
    v_pk_mul_f32 v[34:35], v[32:33], v[32:33] op_sel:[0,0] op_sel_hi:[0,1]
    v_pk_mul_f32 v[40:41], v[38:39], v[32:33] op_sel:[0,0] op_sel_hi:[0,1]
    v_pk_fma_f32 v[120:121], v[236:237], v[234:235], v[120:121] op_sel:[1,1,0] op_sel_hi:[1,0,1] neg_lo:[1,0,0]
    v_pk_fma_f32 v[200:201], v[46:47], v[46:47], v[200:201] op_sel:[1,1,0] op_sel_hi:[1,0,1] neg_lo:[1,0,0]
    v_pk_fma_f32 v[54:55], v[48:49], v[48:49], v[54:55] op_sel:[1,1,0] op_sel_hi:[1,0,1] neg_lo:[1,0,0]
    v_pk_fma_f32 v[206:207], v[46:47], v[52:53], v[206:207] op_sel:[1,1,0] op_sel_hi:[1,0,1] neg_lo:[1,0,0]
    v_pk_fma_f32 v[34:35], v[32:33], v[32:33], v[34:35] op_sel:[1,1,0] op_sel_hi:[1,0,1] neg_lo:[1,0,0]
    v_pk_fma_f32 v[40:41], v[38:39], v[32:33], v[40:41] op_sel:[1,1,0] op_sel_hi:[1,0,1] neg_lo:[1,0,0]
    v_pk_mul_f32 v[122:123], v[120:121], v[48:49] op_sel:[0,0] op_sel_hi:[0,1]
    v_pk_mul_f32 v[202:203], v[200:201], v[46:47] op_sel:[0,0] op_sel_hi:[0,1]
    v_pk_mul_f32 v[208:209], v[200:201], v[52:53] op_sel:[0,0] op_sel_hi:[0,1]
    v_pk_mul_f32 v[124:125], v[120:121], v[54:55] op_sel:[0,0] op_sel_hi:[0,1]
    v_pk_mul_f32 v[36:37], v[34:35], v[32:33] op_sel:[0,0] op_sel_hi:[0,1]
    v_pk_mul_f32 v[42:43], v[38:39], v[34:35] op_sel:[0,0] op_sel_hi:[0,1]
    v_pk_fma_f32 v[122:123], v[120:121], v[48:49], v[122:123] op_sel:[1,1,0] op_sel_hi:[1,0,1] neg_lo:[1,0,0]
    v_pk_fma_f32 v[202:203], v[200:201], v[46:47], v[202:203] op_sel:[1,1,0] op_sel_hi:[1,0,1] neg_lo:[1,0,0]
    v_pk_fma_f32 v[208:209], v[200:201], v[52:53], v[208:209] op_sel:[1,1,0] op_sel_hi:[1,0,1] neg_lo:[1,0,0]
    v_pk_fma_f32 v[124:125], v[120:121], v[54:55], v[124:125] op_sel:[1,1,0] op_sel_hi:[1,0,1] neg_lo:[1,0,0]
    v_pk_fma_f32 v[36:37], v[34:35], v[32:33], v[36:37] op_sel:[1,1,0] op_sel_hi:[1,0,1] neg_lo:[1,0,0]
    v_pk_fma_f32 v[42:43], v[38:39], v[34:35], v[42:43] op_sel:[1,1,0] op_sel_hi:[1,0,1] neg_lo:[1,0,0]
    v_pk_mul_f32 v[126:127], v[122:123], v[54:55] op_sel:[0,0] op_sel_hi:[0,1]
    v_pk_mul_f32 v[210:211], v[202:203], v[52:53] op_sel:[0,0] op_sel_hi:[0,1]
    v_pk_mul_f32 v[196:197], v[52:53], v[52:53] op_sel:[0,0] op_sel_hi:[0,1]
    v_pk_mul_f32 v[198:199], v[206:207], v[52:53] op_sel:[0,0] op_sel_hi:[0,1]
    v_pk_mul_f32 v[44:45], v[38:39], v[36:37] op_sel:[0,0] op_sel_hi:[0,1]
    v_pk_fma_f32 v[126:127], v[122:123], v[54:55], v[126:127] op_sel:[1,1,0] op_sel_hi:[1,0,1] neg_lo:[1,0,0]
    v_pk_fma_f32 v[210:211], v[202:203], v[52:53], v[210:211] op_sel:[1,1,0] op_sel_hi:[1,0,1] neg_lo:[1,0,0]
    v_pk_fma_f32 v[196:197], v[52:53], v[52:53], v[196:197] op_sel:[1,1,0] op_sel_hi:[1,0,1] neg_lo:[1,0,0]
    v_pk_fma_f32 v[198:199], v[206:207], v[52:53], v[198:199] op_sel:[1,1,0] op_sel_hi:[1,0,1] neg_lo:[1,0,0]
    v_pk_fma_f32 v[44:45], v[38:39], v[36:37], v[44:45] op_sel:[1,1,0] op_sel_hi:[1,0,1] neg_lo:[1,0,0]
    v_mov_b32 v56, 0x3f80
    v_cvt_pk_bf16_f32 v57, v46, v47
    v_cvt_pk_bf16_f32 v58, v200, v201
    v_cvt_pk_bf16_f32 v59, v202, v203
    v_cvt_pk_bf16_f32 v60, v52, v53
    v_cvt_pk_bf16_f32 v61, v206, v207
    v_cvt_pk_bf16_f32 v62, v208, v209
    v_cvt_pk_bf16_f32 v63, v210, v211
    v_pk_mul_f32 v[200:201], v[208:209], v[52:53] op_sel:[0,0] op_sel_hi:[0,1]
    v_pk_mul_f32 v[202:203], v[210:211], v[52:53] op_sel:[0,0] op_sel_hi:[0,1]
    v_pk_mul_f32 v[204:205], v[196:197], v[52:53] op_sel:[0,0] op_sel_hi:[0,1]
    v_pk_mul_f32 v[206:207], v[198:199], v[52:53] op_sel:[0,0] op_sel_hi:[0,1]
    v_pk_fma_f32 v[200:201], v[208:209], v[52:53], v[200:201] op_sel:[1,1,0] op_sel_hi:[1,0,1] neg_lo:[1,0,0]
    v_pk_fma_f32 v[202:203], v[210:211], v[52:53], v[202:203] op_sel:[1,1,0] op_sel_hi:[1,0,1] neg_lo:[1,0,0]
    v_pk_fma_f32 v[204:205], v[196:197], v[52:53], v[204:205] op_sel:[1,1,0] op_sel_hi:[1,0,1] neg_lo:[1,0,0]
    v_pk_fma_f32 v[206:207], v[198:199], v[52:53], v[206:207] op_sel:[1,1,0] op_sel_hi:[1,0,1] neg_lo:[1,0,0]
    v_pk_mul_f32 v[208:209], v[200:201], v[52:53] op_sel:[0,0] op_sel_hi:[0,1]
    v_pk_mul_f32 v[210:211], v[202:203], v[52:53] op_sel:[0,0] op_sel_hi:[0,1]
    v_pk_fma_f32 v[208:209], v[200:201], v[52:53], v[208:209] op_sel:[1,1,0] op_sel_hi:[1,0,1] neg_lo:[1,0,0]
    v_pk_fma_f32 v[210:211], v[202:203], v[52:53], v[210:211] op_sel:[1,1,0] op_sel_hi:[1,0,1] neg_lo:[1,0,0]
    v_cvt_pk_bf16_f32 v64, v196, v197
    v_cvt_pk_bf16_f32 v65, v198, v199
    v_cvt_pk_bf16_f32 v66, v200, v201
    v_cvt_pk_bf16_f32 v67, v202, v203
    v_cvt_pk_bf16_f32 v68, v204, v205
    v_cvt_pk_bf16_f32 v69, v206, v207
    v_cvt_pk_bf16_f32 v70, v208, v209
    v_cvt_pk_bf16_f32 v71, v210, v211
    v_cvt_pk_bf16_f32 v146, v120, -v121
    v_cvt_pk_bf16_f32 v150, v122, -v123
    v_cvt_pk_bf16_f32 v154, v124, -v125
    v_cvt_pk_bf16_f32 v155, v124, -v125
    v_cvt_pk_bf16_f32 v158, v126, -v127
    v_cvt_pk_bf16_f32 v159, v126, -v127
    ds_write_addtid_b32 v56 offset:0
    ds_write_addtid_b32 v57 offset:272
    ds_write_addtid_b32 v58 offset:544
    v_pk_mul_f32 v[180:181], v[120:121], v[32:33] op_sel:[0,0] op_sel_hi:[0,1]
    v_pk_mul_f32 v[182:183], v[120:121], v[34:35] op_sel:[0,0] op_sel_hi:[0,1]
    v_pk_mul_f32 v[184:185], v[120:121], v[36:37] op_sel:[0,0] op_sel_hi:[0,1]
    v_pk_mul_f32 v[186:187], v[122:123], v[32:33] op_sel:[0,0] op_sel_hi:[0,1]
    v_pk_fma_f32 v[180:181], v[120:121], v[32:33], v[180:181] op_sel:[1,1,0] op_sel_hi:[1,0,1] neg_lo:[1,0,0]
    v_pk_fma_f32 v[182:183], v[120:121], v[34:35], v[182:183] op_sel:[1,1,0] op_sel_hi:[1,0,1] neg_lo:[1,0,0]
    v_pk_fma_f32 v[184:185], v[120:121], v[36:37], v[184:185] op_sel:[1,1,0] op_sel_hi:[1,0,1] neg_lo:[1,0,0]
    v_pk_fma_f32 v[186:187], v[122:123], v[32:33], v[186:187] op_sel:[1,1,0] op_sel_hi:[1,0,1] neg_lo:[1,0,0]
    ds_write_addtid_b32 v59 offset:816
    ds_write_addtid_b32 v60 offset:1088
    ds_write_addtid_b32 v61 offset:1360
    ds_write_addtid_b32 v62 offset:1632
    v_pk_mul_f32 v[188:189], v[122:123], v[34:35] op_sel:[0,0] op_sel_hi:[0,1]
    v_pk_mul_f32 v[190:191], v[122:123], v[36:37] op_sel:[0,0] op_sel_hi:[0,1]
    v_pk_mul_f32 v[192:193], v[124:125], v[34:35] op_sel:[0,0] op_sel_hi:[0,1]
    v_pk_mul_f32 v[194:195], v[124:125], v[38:39] op_sel:[0,0] op_sel_hi:[0,1]
    v_pk_fma_f32 v[188:189], v[122:123], v[34:35], v[188:189] op_sel:[1,1,0] op_sel_hi:[1,0,1] neg_lo:[1,0,0]
    v_pk_fma_f32 v[190:191], v[122:123], v[36:37], v[190:191] op_sel:[1,1,0] op_sel_hi:[1,0,1] neg_lo:[1,0,0]
    v_pk_fma_f32 v[192:193], v[124:125], v[34:35], v[192:193] op_sel:[1,1,0] op_sel_hi:[1,0,1] neg_lo:[1,0,0]
    v_pk_fma_f32 v[194:195], v[124:125], v[38:39], v[194:195] op_sel:[1,1,0] op_sel_hi:[1,0,1] neg_lo:[1,0,0]
    ds_write_addtid_b32 v63 offset:1904
    ds_write_addtid_b32 v64 offset:2176
    ds_write_addtid_b32 v65 offset:2448
    ds_write_addtid_b32 v66 offset:2720
    v_cvt_pk_bf16_f32 v147, v180, -v181
    v_cvt_pk_bf16_f32 v148, v182, -v183
    v_cvt_pk_bf16_f32 v149, v184, -v185
    v_cvt_pk_bf16_f32 v151, v186, -v187
    v_cvt_pk_bf16_f32 v152, v188, -v189
    v_cvt_pk_bf16_f32 v153, v190, -v191
    v_cvt_pk_bf16_f32 v156, v192, -v193
    v_cvt_pk_bf16_f32 v157, v194, -v195
    ds_write_addtid_b32 v67 offset:2992
    ds_write_addtid_b32 v68 offset:3264
    ds_write_addtid_b32 v69 offset:3536
    ds_write_addtid_b32 v70 offset:3808
    v_pk_mul_f32 v[180:181], v[126:127], v[34:35] op_sel:[0,0] op_sel_hi:[0,1]
    v_pk_mul_f32 v[182:183], v[126:127], v[38:39] op_sel:[0,0] op_sel_hi:[0,1]
    v_pk_fma_f32 v[180:181], v[126:127], v[34:35], v[180:181] op_sel:[1,1,0] op_sel_hi:[1,0,1] neg_lo:[1,0,0]
    v_pk_fma_f32 v[182:183], v[126:127], v[38:39], v[182:183] op_sel:[1,1,0] op_sel_hi:[1,0,1] neg_lo:[1,0,0]
    ds_write_addtid_b32 v71 offset:4080
    ds_read_b128 v[72:75], v242 offset:0
    ds_read_b128 v[76:79], v242 offset:64
    ds_read_b128 v[80:83], v242 offset:128
    ds_read_b128 v[84:87], v242 offset:192
    v_cvt_pk_bf16_f32 v160, v180, -v181
    v_cvt_pk_bf16_f32 v161, v182, -v183
    v_pk_mul_f32 v[180:181], v[120:121], v[38:39] op_sel:[0,0] op_sel_hi:[0,1]
    v_pk_mul_f32 v[182:183], v[120:121], v[40:41] op_sel:[0,0] op_sel_hi:[0,1]
    v_pk_mul_f32 v[184:185], v[120:121], v[42:43] op_sel:[0,0] op_sel_hi:[0,1]
    v_pk_mul_f32 v[186:187], v[120:121], v[44:45] op_sel:[0,0] op_sel_hi:[0,1]
    v_pk_fma_f32 v[180:181], v[120:121], v[38:39], v[180:181] op_sel:[1,1,0] op_sel_hi:[1,0,1] neg_lo:[1,0,0]
    v_pk_fma_f32 v[182:183], v[120:121], v[40:41], v[182:183] op_sel:[1,1,0] op_sel_hi:[1,0,1] neg_lo:[1,0,0]
    v_pk_fma_f32 v[184:185], v[120:121], v[42:43], v[184:185] op_sel:[1,1,0] op_sel_hi:[1,0,1] neg_lo:[1,0,0]
    v_pk_fma_f32 v[186:187], v[120:121], v[44:45], v[186:187] op_sel:[1,1,0] op_sel_hi:[1,0,1] neg_lo:[1,0,0]
    ds_write_addtid_b32 v146 offset:4352
    ds_write_addtid_b32 v147 offset:4624
    ds_write_addtid_b32 v148 offset:4896
    ds_write_addtid_b32 v149 offset:5168
    ds_write_addtid_b32 v150 offset:5440
    v_pk_mul_f32 v[188:189], v[122:123], v[38:39] op_sel:[0,0] op_sel_hi:[0,1]
    v_pk_mul_f32 v[190:191], v[122:123], v[40:41] op_sel:[0,0] op_sel_hi:[0,1]
    v_pk_mul_f32 v[192:193], v[122:123], v[42:43] op_sel:[0,0] op_sel_hi:[0,1]
    v_pk_mul_f32 v[194:195], v[122:123], v[44:45] op_sel:[0,0] op_sel_hi:[0,1]
    v_pk_fma_f32 v[188:189], v[122:123], v[38:39], v[188:189] op_sel:[1,1,0] op_sel_hi:[1,0,1] neg_lo:[1,0,0]
    v_pk_fma_f32 v[190:191], v[122:123], v[40:41], v[190:191] op_sel:[1,1,0] op_sel_hi:[1,0,1] neg_lo:[1,0,0]
    v_pk_fma_f32 v[192:193], v[122:123], v[42:43], v[192:193] op_sel:[1,1,0] op_sel_hi:[1,0,1] neg_lo:[1,0,0]
    v_pk_fma_f32 v[194:195], v[122:123], v[44:45], v[194:195] op_sel:[1,1,0] op_sel_hi:[1,0,1] neg_lo:[1,0,0]
    ds_write_addtid_b32 v151 offset:5712
    ds_write_addtid_b32 v152 offset:5984
    ds_write_addtid_b32 v153 offset:6256
    ds_write_addtid_b32 v154 offset:6528
    v_cvt_pk_bf16_f32 v56, v180, -v181
    v_cvt_pk_bf16_f32 v57, v182, -v183
    v_cvt_pk_bf16_f32 v58, v184, -v185
    v_cvt_pk_bf16_f32 v59, v186, -v187
    v_cvt_pk_bf16_f32 v60, v188, -v189
    v_cvt_pk_bf16_f32 v61, v190, -v191
    v_cvt_pk_bf16_f32 v62, v192, -v193
    v_cvt_pk_bf16_f32 v63, v194, -v195
    ds_write_addtid_b32 v155 offset:6800
    ds_write_addtid_b32 v156 offset:7072
    ds_write_addtid_b32 v157 offset:7344
    ds_write_addtid_b32 v158 offset:7616
    v_pk_mul_f32 v[180:181], v[124:125], v[38:39] op_sel:[0,0] op_sel_hi:[0,1]
    v_pk_mul_f32 v[182:183], v[124:125], v[42:43] op_sel:[0,0] op_sel_hi:[0,1]
    v_pk_mul_f32 v[184:185], v[124:125], v[46:47] op_sel:[0,0] op_sel_hi:[0,1]
    v_pk_mul_f32 v[186:187], v[126:127], v[38:39] op_sel:[0,0] op_sel_hi:[0,1]
    v_pk_fma_f32 v[180:181], v[124:125], v[38:39], v[180:181] op_sel:[1,1,0] op_sel_hi:[1,0,1] neg_lo:[1,0,0]
    v_pk_fma_f32 v[182:183], v[124:125], v[42:43], v[182:183] op_sel:[1,1,0] op_sel_hi:[1,0,1] neg_lo:[1,0,0]
    v_pk_fma_f32 v[184:185], v[124:125], v[46:47], v[184:185] op_sel:[1,1,0] op_sel_hi:[1,0,1] neg_lo:[1,0,0]
    v_pk_fma_f32 v[186:187], v[126:127], v[38:39], v[186:187] op_sel:[1,1,0] op_sel_hi:[1,0,1] neg_lo:[1,0,0]
    ds_write_addtid_b32 v159 offset:7888
    ds_write_addtid_b32 v160 offset:8160
    ds_write_addtid_b32 v161 offset:8432
    ds_read_b128 v[88:91], v242 offset:4352
    ds_read_b128 v[92:95], v242 offset:4416
    ds_read_b128 v[96:99], v242 offset:4480
    ds_read_b128 v[100:103], v242 offset:4544
    v_pk_mul_f32 v[188:189], v[126:127], v[42:43] op_sel:[0,0] op_sel_hi:[0,1]
    v_pk_mul_f32 v[190:191], v[126:127], v[46:47] op_sel:[0,0] op_sel_hi:[0,1]
    v_pk_fma_f32 v[188:189], v[126:127], v[42:43], v[188:189] op_sel:[1,1,0] op_sel_hi:[1,0,1] neg_lo:[1,0,0]
    v_pk_fma_f32 v[190:191], v[126:127], v[46:47], v[190:191] op_sel:[1,1,0] op_sel_hi:[1,0,1] neg_lo:[1,0,0]
    v_cvt_pk_bf16_f32 v64, v180, -v181
    v_cvt_pk_bf16_f32 v65, v180, -v181
    v_cvt_pk_bf16_f32 v66, v182, -v183
    v_cvt_pk_bf16_f32 v67, v184, -v185
    v_cvt_pk_bf16_f32 v68, v186, -v187
    v_cvt_pk_bf16_f32 v69, v186, -v187
    v_cvt_pk_bf16_f32 v70, v188, -v189
    v_cvt_pk_bf16_f32 v71, v190, -v191
    s_waitcnt lgkmcnt(3)
    v_mfma_f32_16x16x32_bf16 v[128:131], v[88:91], v[72:75], 0
    s_waitcnt lgkmcnt(2)
    v_mfma_f32_16x16x32_bf16 v[128:131], v[92:95], v[76:79], v[128:131]
    s_waitcnt lgkmcnt(1)
    v_mfma_f32_16x16x32_bf16 v[128:131], v[96:99], v[80:83], v[128:131]
    s_waitcnt lgkmcnt(0)
    v_mfma_f32_16x16x32_bf16 v[128:131], v[100:103], v[84:87], v[128:131]
    v_pk_mul_f32 v[212:213], v[120:121], v[50:51] op_sel:[0,0] op_sel_hi:[0,1]
    v_pk_mul_f32 v[214:215], v[122:123], v[50:51] op_sel:[0,0] op_sel_hi:[0,1]
    v_pk_mul_f32 v[216:217], v[124:125], v[50:51] op_sel:[0,0] op_sel_hi:[0,1]
    v_pk_mul_f32 v[218:219], v[126:127], v[50:51] op_sel:[0,0] op_sel_hi:[0,1]
    v_pk_fma_f32 v[212:213], v[120:121], v[50:51], v[212:213] op_sel:[1,1,0] op_sel_hi:[1,0,1] neg_lo:[1,0,0]
    v_pk_fma_f32 v[214:215], v[122:123], v[50:51], v[214:215] op_sel:[1,1,0] op_sel_hi:[1,0,1] neg_lo:[1,0,0]
    v_pk_fma_f32 v[216:217], v[124:125], v[50:51], v[216:217] op_sel:[1,1,0] op_sel_hi:[1,0,1] neg_lo:[1,0,0]
    v_pk_fma_f32 v[218:219], v[126:127], v[50:51], v[218:219] op_sel:[1,1,0] op_sel_hi:[1,0,1] neg_lo:[1,0,0]
    ds_write_addtid_b32 v56 offset:4352
    ds_write_addtid_b32 v57 offset:4624
    ds_write_addtid_b32 v58 offset:4896
    ds_write_addtid_b32 v59 offset:5168
    v_cvt_pk_bf16_f32 v147, v212, -v213
    v_cvt_pk_bf16_f32 v151, v214, -v215
    v_cvt_pk_bf16_f32 v155, v216, -v217
    v_cvt_pk_bf16_f32 v159, v218, -v219
    ds_write_addtid_b32 v60 offset:5440
    ds_write_addtid_b32 v61 offset:5712
    v_pk_mul_f32 v[180:181], v[120:121], v[46:47] op_sel:[0,0] op_sel_hi:[0,1]
    v_pk_mul_f32 v[182:183], v[212:213], v[38:39] op_sel:[0,0] op_sel_hi:[0,1]
    v_pk_mul_f32 v[184:185], v[212:213], v[46:47] op_sel:[0,0] op_sel_hi:[0,1]
    v_pk_mul_f32 v[186:187], v[122:123], v[46:47] op_sel:[0,0] op_sel_hi:[0,1]
    v_pk_fma_f32 v[180:181], v[120:121], v[46:47], v[180:181] op_sel:[1,1,0] op_sel_hi:[1,0,1] neg_lo:[1,0,0]
    v_pk_fma_f32 v[182:183], v[212:213], v[38:39], v[182:183] op_sel:[1,1,0] op_sel_hi:[1,0,1] neg_lo:[1,0,0]
    v_pk_fma_f32 v[184:185], v[212:213], v[46:47], v[184:185] op_sel:[1,1,0] op_sel_hi:[1,0,1] neg_lo:[1,0,0]
    v_pk_fma_f32 v[186:187], v[122:123], v[46:47], v[186:187] op_sel:[1,1,0] op_sel_hi:[1,0,1] neg_lo:[1,0,0]
    ds_write_addtid_b32 v62 offset:5984
    ds_write_addtid_b32 v63 offset:6256
    ds_write_addtid_b32 v64 offset:6528
    ds_write_addtid_b32 v65 offset:6800
    v_pk_mul_f32 v[188:189], v[214:215], v[38:39] op_sel:[0,0] op_sel_hi:[0,1]
    v_pk_mul_f32 v[190:191], v[214:215], v[46:47] op_sel:[0,0] op_sel_hi:[0,1]
    v_pk_mul_f32 v[192:193], v[124:125], v[46:47] op_sel:[0,0] op_sel_hi:[0,1]
    v_pk_mul_f32 v[194:195], v[216:217], v[38:39] op_sel:[0,0] op_sel_hi:[0,1]
    v_pk_fma_f32 v[188:189], v[214:215], v[38:39], v[188:189] op_sel:[1,1,0] op_sel_hi:[1,0,1] neg_lo:[1,0,0]
    v_pk_fma_f32 v[190:191], v[214:215], v[46:47], v[190:191] op_sel:[1,1,0] op_sel_hi:[1,0,1] neg_lo:[1,0,0]
    v_pk_fma_f32 v[192:193], v[124:125], v[46:47], v[192:193] op_sel:[1,1,0] op_sel_hi:[1,0,1] neg_lo:[1,0,0]
    v_pk_fma_f32 v[194:195], v[216:217], v[38:39], v[194:195] op_sel:[1,1,0] op_sel_hi:[1,0,1] neg_lo:[1,0,0]
    ds_write_addtid_b32 v66 offset:7072
    ds_write_addtid_b32 v67 offset:7344
    ds_write_addtid_b32 v68 offset:7616
    ds_write_addtid_b32 v69 offset:7888
    v_cvt_pk_bf16_f32 v146, v180, -v181
    v_cvt_pk_bf16_f32 v148, v182, -v183
    v_cvt_pk_bf16_f32 v149, v184, -v185
    v_cvt_pk_bf16_f32 v150, v186, -v187
    v_cvt_pk_bf16_f32 v152, v188, -v189
    v_cvt_pk_bf16_f32 v153, v190, -v191
    v_cvt_pk_bf16_f32 v154, v192, -v193
    v_cvt_pk_bf16_f32 v156, v194, -v195
    ds_write_addtid_b32 v70 offset:8160
    ds_write_addtid_b32 v71 offset:8432
    ds_read_b128 v[88:91], v242 offset:4352
    ds_read_b128 v[92:95], v242 offset:4416
    ds_read_b128 v[96:99], v242 offset:4480
    ds_read_b128 v[100:103], v242 offset:4544
    v_pk_mul_f32 v[180:181], v[216:217], v[46:47] op_sel:[0,0] op_sel_hi:[0,1]
    v_pk_mul_f32 v[182:183], v[126:127], v[46:47] op_sel:[0,0] op_sel_hi:[0,1]
    v_pk_mul_f32 v[184:185], v[218:219], v[38:39] op_sel:[0,0] op_sel_hi:[0,1]
    v_pk_mul_f32 v[186:187], v[218:219], v[46:47] op_sel:[0,0] op_sel_hi:[0,1]
    v_pk_fma_f32 v[180:181], v[216:217], v[46:47], v[180:181] op_sel:[1,1,0] op_sel_hi:[1,0,1] neg_lo:[1,0,0]
    v_pk_fma_f32 v[182:183], v[126:127], v[46:47], v[182:183] op_sel:[1,1,0] op_sel_hi:[1,0,1] neg_lo:[1,0,0]
    v_pk_fma_f32 v[184:185], v[218:219], v[38:39], v[184:185] op_sel:[1,1,0] op_sel_hi:[1,0,1] neg_lo:[1,0,0]
    v_pk_fma_f32 v[186:187], v[218:219], v[46:47], v[186:187] op_sel:[1,1,0] op_sel_hi:[1,0,1] neg_lo:[1,0,0]
    s_waitcnt lgkmcnt(3)
    v_mfma_f32_16x16x32_bf16 v[132:135], v[88:91], v[72:75], 0
    s_waitcnt lgkmcnt(2)
    v_mfma_f32_16x16x32_bf16 v[132:135], v[92:95], v[76:79], v[132:135]
    s_waitcnt lgkmcnt(1)
    v_mfma_f32_16x16x32_bf16 v[132:135], v[96:99], v[80:83], v[132:135]
    s_waitcnt lgkmcnt(0)
    v_mfma_f32_16x16x32_bf16 v[132:135], v[100:103], v[84:87], v[132:135]
    v_cvt_pk_bf16_f32 v157, v180, -v181
    v_cvt_pk_bf16_f32 v158, v182, -v183
    v_cvt_pk_bf16_f32 v160, v184, -v185
    v_cvt_pk_bf16_f32 v161, v186, -v187
    v_pk_mul_f32 v[220:221], v[212:213], v[50:51] op_sel:[0,0] op_sel_hi:[0,1]
    v_pk_mul_f32 v[222:223], v[214:215], v[50:51] op_sel:[0,0] op_sel_hi:[0,1]
    v_pk_mul_f32 v[224:225], v[216:217], v[50:51] op_sel:[0,0] op_sel_hi:[0,1]
    v_pk_mul_f32 v[226:227], v[218:219], v[50:51] op_sel:[0,0] op_sel_hi:[0,1]
    v_pk_fma_f32 v[220:221], v[212:213], v[50:51], v[220:221] op_sel:[1,1,0] op_sel_hi:[1,0,1] neg_lo:[1,0,0]
    v_pk_fma_f32 v[222:223], v[214:215], v[50:51], v[222:223] op_sel:[1,1,0] op_sel_hi:[1,0,1] neg_lo:[1,0,0]
    v_pk_fma_f32 v[224:225], v[216:217], v[50:51], v[224:225] op_sel:[1,1,0] op_sel_hi:[1,0,1] neg_lo:[1,0,0]
    v_pk_fma_f32 v[226:227], v[218:219], v[50:51], v[226:227] op_sel:[1,1,0] op_sel_hi:[1,0,1] neg_lo:[1,0,0]
    ds_write_addtid_b32 v146 offset:4352
    ds_write_addtid_b32 v147 offset:4624
    ds_write_addtid_b32 v148 offset:4896
    ds_write_addtid_b32 v149 offset:5168
    v_pk_mul_f32 v[212:213], v[220:221], v[50:51] op_sel:[0,0] op_sel_hi:[0,1]
    v_pk_mul_f32 v[214:215], v[222:223], v[50:51] op_sel:[0,0] op_sel_hi:[0,1]
    v_pk_mul_f32 v[216:217], v[224:225], v[50:51] op_sel:[0,0] op_sel_hi:[0,1]
    v_pk_mul_f32 v[218:219], v[226:227], v[50:51] op_sel:[0,0] op_sel_hi:[0,1]
    v_pk_fma_f32 v[212:213], v[220:221], v[50:51], v[212:213] op_sel:[1,1,0] op_sel_hi:[1,0,1] neg_lo:[1,0,0]
    v_pk_fma_f32 v[214:215], v[222:223], v[50:51], v[214:215] op_sel:[1,1,0] op_sel_hi:[1,0,1] neg_lo:[1,0,0]
    v_pk_fma_f32 v[216:217], v[224:225], v[50:51], v[216:217] op_sel:[1,1,0] op_sel_hi:[1,0,1] neg_lo:[1,0,0]
    v_pk_fma_f32 v[218:219], v[226:227], v[50:51], v[218:219] op_sel:[1,1,0] op_sel_hi:[1,0,1] neg_lo:[1,0,0]
    ds_write_addtid_b32 v150 offset:5440
    ds_write_addtid_b32 v151 offset:5712
    ds_write_addtid_b32 v152 offset:5984
    ds_write_addtid_b32 v153 offset:6256
    v_cvt_pk_bf16_f32 v56, v220, -v221
    v_cvt_pk_bf16_f32 v58, v222, -v223
    v_cvt_pk_bf16_f32 v60, v224, -v225
    v_cvt_pk_bf16_f32 v62, v226, -v227
    v_cvt_pk_bf16_f32 v64, v212, -v213
    v_cvt_pk_bf16_f32 v66, v214, -v215
    v_cvt_pk_bf16_f32 v68, v216, -v217
    v_cvt_pk_bf16_f32 v70, v218, -v219
    ds_write_addtid_b32 v154 offset:6528
    ds_write_addtid_b32 v155 offset:6800
    ds_write_addtid_b32 v156 offset:7072
    ds_write_addtid_b32 v157 offset:7344
    v_pk_mul_f32 v[180:181], v[220:221], v[46:47] op_sel:[0,0] op_sel_hi:[0,1]
    v_pk_mul_f32 v[182:183], v[222:223], v[46:47] op_sel:[0,0] op_sel_hi:[0,1]
    v_pk_mul_f32 v[184:185], v[224:225], v[46:47] op_sel:[0,0] op_sel_hi:[0,1]
    v_pk_mul_f32 v[186:187], v[226:227], v[46:47] op_sel:[0,0] op_sel_hi:[0,1]
    v_pk_fma_f32 v[180:181], v[220:221], v[46:47], v[180:181] op_sel:[1,1,0] op_sel_hi:[1,0,1] neg_lo:[1,0,0]
    v_pk_fma_f32 v[182:183], v[222:223], v[46:47], v[182:183] op_sel:[1,1,0] op_sel_hi:[1,0,1] neg_lo:[1,0,0]
    v_pk_fma_f32 v[184:185], v[224:225], v[46:47], v[184:185] op_sel:[1,1,0] op_sel_hi:[1,0,1] neg_lo:[1,0,0]
    v_pk_fma_f32 v[186:187], v[226:227], v[46:47], v[186:187] op_sel:[1,1,0] op_sel_hi:[1,0,1] neg_lo:[1,0,0]
    ds_write_addtid_b32 v158 offset:7616
    ds_write_addtid_b32 v159 offset:7888
    ds_write_addtid_b32 v160 offset:8160
    ds_write_addtid_b32 v161 offset:8432
    v_pk_mul_f32 v[188:189], v[212:213], v[46:47] op_sel:[0,0] op_sel_hi:[0,1]
    v_pk_mul_f32 v[190:191], v[214:215], v[46:47] op_sel:[0,0] op_sel_hi:[0,1]
    v_pk_mul_f32 v[192:193], v[216:217], v[46:47] op_sel:[0,0] op_sel_hi:[0,1]
    v_pk_mul_f32 v[194:195], v[218:219], v[46:47] op_sel:[0,0] op_sel_hi:[0,1]
    v_pk_fma_f32 v[188:189], v[212:213], v[46:47], v[188:189] op_sel:[1,1,0] op_sel_hi:[1,0,1] neg_lo:[1,0,0]
    v_pk_fma_f32 v[190:191], v[214:215], v[46:47], v[190:191] op_sel:[1,1,0] op_sel_hi:[1,0,1] neg_lo:[1,0,0]
    v_pk_fma_f32 v[192:193], v[216:217], v[46:47], v[192:193] op_sel:[1,1,0] op_sel_hi:[1,0,1] neg_lo:[1,0,0]
    v_pk_fma_f32 v[194:195], v[218:219], v[46:47], v[194:195] op_sel:[1,1,0] op_sel_hi:[1,0,1] neg_lo:[1,0,0]
    ds_read_b128 v[88:91], v242 offset:4352
    ds_read_b128 v[92:95], v242 offset:4416
    ds_read_b128 v[96:99], v242 offset:4480
    ds_read_b128 v[100:103], v242 offset:4544
    s_waitcnt lgkmcnt(3)
    v_mfma_f32_16x16x32_bf16 v[136:139], v[88:91], v[72:75], 0
    s_waitcnt lgkmcnt(2)
    v_mfma_f32_16x16x32_bf16 v[136:139], v[92:95], v[76:79], v[136:139]
    s_waitcnt lgkmcnt(1)
    v_mfma_f32_16x16x32_bf16 v[136:139], v[96:99], v[80:83], v[136:139]
    s_waitcnt lgkmcnt(0)
    v_mfma_f32_16x16x32_bf16 v[136:139], v[100:103], v[84:87], v[136:139]
    v_cvt_pk_bf16_f32 v57, v180, -v181
    v_cvt_pk_bf16_f32 v59, v182, -v183
    v_cvt_pk_bf16_f32 v61, v184, -v185
    v_cvt_pk_bf16_f32 v63, v186, -v187
    v_cvt_pk_bf16_f32 v65, v188, -v189
    v_cvt_pk_bf16_f32 v67, v190, -v191
    v_cvt_pk_bf16_f32 v69, v192, -v193
    v_cvt_pk_bf16_f32 v71, v194, -v195
    ds_write_addtid_b32 v56 offset:4352
    ds_write_addtid_b32 v57 offset:4624
    ds_write_addtid_b32 v58 offset:4896
    ds_write_addtid_b32 v59 offset:5168
    ds_write_addtid_b32 v60 offset:5440
    ds_write_addtid_b32 v61 offset:5712
    ds_write_addtid_b32 v62 offset:5984
    ds_write_addtid_b32 v63 offset:6256
    ds_write_addtid_b32 v64 offset:6528
    ds_write_addtid_b32 v65 offset:6800
    ds_write_addtid_b32 v66 offset:7072
    ds_write_addtid_b32 v67 offset:7344
    ds_write_addtid_b32 v68 offset:7616
    ds_write_addtid_b32 v69 offset:7888
    ds_write_addtid_b32 v70 offset:8160
    ds_write_addtid_b32 v71 offset:8432
    ds_read_b128 v[88:91], v242 offset:4352
    ds_read_b128 v[92:95], v242 offset:4416
    ds_read_b128 v[96:99], v242 offset:4480
    ds_read_b128 v[100:103], v242 offset:4544
    s_waitcnt lgkmcnt(3)
    v_mfma_f32_16x16x32_bf16 v[140:143], v[88:91], v[72:75], 0
    s_waitcnt lgkmcnt(2)
    v_mfma_f32_16x16x32_bf16 v[140:143], v[92:95], v[76:79], v[140:143]
    s_waitcnt lgkmcnt(1)
    v_mfma_f32_16x16x32_bf16 v[140:143], v[96:99], v[80:83], v[140:143]
    s_waitcnt lgkmcnt(0)
    v_mfma_f32_16x16x32_bf16 v[140:143], v[100:103], v[84:87], v[140:143]
    v_lshlrev_b32 v243, 4, v1
    v_add_u32 v243, s80, v243
    s_nop 6
    ds_write_b128 v243, v[128:131] offset:0
    ds_write_b128 v243, v[132:135] offset:1024
    ds_write_b128 v243, v[136:139] offset:2048
    ds_write_b128 v243, v[140:143] offset:3072
    s_cmp_ge_u32 s38, 4
    s_cbranch_scc1 L_Haux_ret
    s_waitcnt lgkmcnt(0)
    s_barrier
    ds_read_b128 v[48:51], v18 offset:24576
    ds_read_b128 v[52:55], v18 offset:26624
    ds_read_b64_tr_b16 v[32:33], v10 offset:24576
    ds_read_b64_tr_b16 v[34:35], v10 offset:25600
    ds_read_b64_tr_b16 v[36:37], v11 offset:24576
    ds_read_b64_tr_b16 v[38:39], v11 offset:25600
    ds_read_b64_tr_b16 v[40:41], v12 offset:24576
    ds_read_b64_tr_b16 v[42:43], v12 offset:25600
    ds_read_b64_tr_b16 v[44:45], v13 offset:24576
    ds_read_b64_tr_b16 v[46:47], v13 offset:25600
    ds_read_b128 v[56:59], v19 offset:24576
    ds_read_b128 v[60:63], v19 offset:26624
    s_waitcnt lgkmcnt(8)
    v_mfma_f32_32x32x16_bf16 v[64:79], v[32:35], v[48:51], 0
    v_mfma_f32_32x32x16_bf16 v[80:95], v[32:35], v[52:55], 0
    ds_read_b64_tr_b16 v[32:33], v10 offset:28672
    ds_read_b64_tr_b16 v[34:35], v10 offset:29696
    s_waitcnt lgkmcnt(8)
    v_mfma_f32_32x32x16_bf16 v[96:111], v[36:39], v[48:51], 0
    v_mfma_f32_32x32x16_bf16 v[112:127], v[36:39], v[52:55], 0
    ds_read_b64_tr_b16 v[36:37], v11 offset:28672
    ds_read_b64_tr_b16 v[38:39], v11 offset:29696
    s_waitcnt lgkmcnt(8)
    v_mfma_f32_32x32x16_bf16 v[128:143], v[40:43], v[48:51], 0
    v_mfma_f32_32x32x16_bf16 v[144:159], v[40:43], v[52:55], 0
    ds_read_b64_tr_b16 v[40:41], v12 offset:28672
    ds_read_b64_tr_b16 v[42:43], v12 offset:29696
    s_waitcnt lgkmcnt(8)
    v_mfma_f32_32x32x16_bf16 v[160:175], v[44:47], v[48:51], 0
    v_mfma_f32_32x32x16_bf16 v[176:191], v[44:47], v[52:55], 0
    ds_read_b64_tr_b16 v[44:45], v13 offset:28672
    ds_read_b64_tr_b16 v[46:47], v13 offset:29696
    s_barrier
    ds_read_b128 v[48:51], v18 offset:49152
    ds_read_b128 v[52:55], v18 offset:51200
    s_waitcnt lgkmcnt(8)
    v_mfma_f32_32x32x16_bf16 v[64:79], v[32:35], v[56:59], v[64:79]
    v_mfma_f32_32x32x16_bf16 v[80:95], v[32:35], v[60:63], v[80:95]
    ds_read_b64_tr_b16 v[32:33], v10 offset:49152
    ds_read_b64_tr_b16 v[34:35], v10 offset:50176
    s_waitcnt lgkmcnt(8)
    v_mfma_f32_32x32x16_bf16 v[96:111], v[36:39], v[56:59], v[96:111]
    v_mfma_f32_32x32x16_bf16 v[112:127], v[36:39], v[60:63], v[112:127]
    ds_read_b64_tr_b16 v[36:37], v11 offset:49152
    ds_read_b64_tr_b16 v[38:39], v11 offset:50176
    s_waitcnt lgkmcnt(8)
    v_mfma_f32_32x32x16_bf16 v[128:143], v[40:43], v[56:59], v[128:143]
    v_mfma_f32_32x32x16_bf16 v[144:159], v[40:43], v[60:63], v[144:159]
    ds_read_b64_tr_b16 v[40:41], v12 offset:49152
    ds_read_b64_tr_b16 v[42:43], v12 offset:50176
    s_waitcnt lgkmcnt(8)
    v_mfma_f32_32x32x16_bf16 v[160:175], v[44:47], v[56:59], v[160:175]
    v_mfma_f32_32x32x16_bf16 v[176:191], v[44:47], v[60:63], v[176:191]
    ds_read_b64_tr_b16 v[44:45], v13 offset:49152
    ds_read_b64_tr_b16 v[46:47], v13 offset:50176
    ds_read_b128 v[56:59], v19 offset:49152
    ds_read_b128 v[60:63], v19 offset:51200
    s_waitcnt lgkmcnt(8)
    v_mfma_f32_32x32x16_bf16 v[64:79], v[32:35], v[48:51], v[64:79]
    v_mfma_f32_32x32x16_bf16 v[80:95], v[32:35], v[52:55], v[80:95]
    ds_read_b64_tr_b16 v[32:33], v10 offset:53248
    ds_read_b64_tr_b16 v[34:35], v10 offset:54272
    s_waitcnt lgkmcnt(8)
    v_mfma_f32_32x32x16_bf16 v[96:111], v[36:39], v[48:51], v[96:111]
    v_mfma_f32_32x32x16_bf16 v[112:127], v[36:39], v[52:55], v[112:127]
    ds_read_b64_tr_b16 v[36:37], v11 offset:53248
    ds_read_b64_tr_b16 v[38:39], v11 offset:54272
    s_waitcnt lgkmcnt(8)
    v_mfma_f32_32x32x16_bf16 v[128:143], v[40:43], v[48:51], v[128:143]
    v_mfma_f32_32x32x16_bf16 v[144:159], v[40:43], v[52:55], v[144:159]
    ds_read_b64_tr_b16 v[40:41], v12 offset:53248
    ds_read_b64_tr_b16 v[42:43], v12 offset:54272
    s_waitcnt lgkmcnt(8)
    v_mfma_f32_32x32x16_bf16 v[160:175], v[44:47], v[48:51], v[160:175]
    v_mfma_f32_32x32x16_bf16 v[176:191], v[44:47], v[52:55], v[176:191]
    ds_read_b64_tr_b16 v[44:45], v13 offset:53248
    ds_read_b64_tr_b16 v[46:47], v13 offset:54272
    s_barrier
    ds_read_b128 v[48:51], v20 offset:0
    ds_read_b128 v[52:55], v20 offset:2048
    s_waitcnt lgkmcnt(8)
    v_mfma_f32_32x32x16_bf16 v[64:79], v[32:35], v[56:59], v[64:79]
    v_mfma_f32_32x32x16_bf16 v[80:95], v[32:35], v[60:63], v[80:95]
    ds_read_b64_tr_b16 v[32:33], v14 offset:0
    ds_read_b64_tr_b16 v[34:35], v14 offset:1024
    s_waitcnt lgkmcnt(8)
    v_mfma_f32_32x32x16_bf16 v[96:111], v[36:39], v[56:59], v[96:111]
    v_mfma_f32_32x32x16_bf16 v[112:127], v[36:39], v[60:63], v[112:127]
    ds_read_b64_tr_b16 v[36:37], v15 offset:0
    ds_read_b64_tr_b16 v[38:39], v15 offset:1024
    s_waitcnt lgkmcnt(8)
    v_mfma_f32_32x32x16_bf16 v[128:143], v[40:43], v[56:59], v[128:143]
    v_mfma_f32_32x32x16_bf16 v[144:159], v[40:43], v[60:63], v[144:159]
    ds_read_b64_tr_b16 v[40:41], v16 offset:0
    ds_read_b64_tr_b16 v[42:43], v16 offset:1024
    s_waitcnt lgkmcnt(8)
    v_mfma_f32_32x32x16_bf16 v[160:175], v[44:47], v[56:59], v[160:175]
    v_mfma_f32_32x32x16_bf16 v[176:191], v[44:47], v[60:63], v[176:191]
    ds_read_b64_tr_b16 v[44:45], v17 offset:0
    ds_read_b64_tr_b16 v[46:47], v17 offset:1024
    ds_read_b128 v[56:59], v21 offset:0
    ds_read_b128 v[60:63], v21 offset:2048
    s_waitcnt lgkmcnt(8)
    v_mfma_f32_32x32x16_bf16 v[64:79], v[32:35], v[48:51], v[64:79]
    v_mfma_f32_32x32x16_bf16 v[80:95], v[32:35], v[52:55], v[80:95]
    ds_read_b64_tr_b16 v[32:33], v14 offset:4096
    ds_read_b64_tr_b16 v[34:35], v14 offset:5120
    s_waitcnt lgkmcnt(8)
    v_mfma_f32_32x32x16_bf16 v[96:111], v[36:39], v[48:51], v[96:111]
    v_mfma_f32_32x32x16_bf16 v[112:127], v[36:39], v[52:55], v[112:127]
    ds_read_b64_tr_b16 v[36:37], v15 offset:4096
    ds_read_b64_tr_b16 v[38:39], v15 offset:5120
    s_waitcnt lgkmcnt(8)
    v_mfma_f32_32x32x16_bf16 v[128:143], v[40:43], v[48:51], v[128:143]
    v_mfma_f32_32x32x16_bf16 v[144:159], v[40:43], v[52:55], v[144:159]
    ds_read_b64_tr_b16 v[40:41], v16 offset:4096
    ds_read_b64_tr_b16 v[42:43], v16 offset:5120
    s_waitcnt lgkmcnt(8)
    v_mfma_f32_32x32x16_bf16 v[160:175], v[44:47], v[48:51], v[160:175]
    v_mfma_f32_32x32x16_bf16 v[176:191], v[44:47], v[52:55], v[176:191]
    ds_read_b64_tr_b16 v[44:45], v17 offset:4096
    ds_read_b64_tr_b16 v[46:47], v17 offset:5120
    s_barrier
    ds_read_b128 v[48:51], v20 offset:24576
    ds_read_b128 v[52:55], v20 offset:26624
    s_waitcnt lgkmcnt(8)
    v_mfma_f32_32x32x16_bf16 v[64:79], v[32:35], v[56:59], v[64:79]
    v_mfma_f32_32x32x16_bf16 v[80:95], v[32:35], v[60:63], v[80:95]
    ds_read_b64_tr_b16 v[32:33], v14 offset:24576
    ds_read_b64_tr_b16 v[34:35], v14 offset:25600
    s_waitcnt lgkmcnt(8)
    v_mfma_f32_32x32x16_bf16 v[96:111], v[36:39], v[56:59], v[96:111]
    v_mfma_f32_32x32x16_bf16 v[112:127], v[36:39], v[60:63], v[112:127]
    ds_read_b64_tr_b16 v[36:37], v15 offset:24576
    ds_read_b64_tr_b16 v[38:39], v15 offset:25600
    s_waitcnt lgkmcnt(8)
    v_mfma_f32_32x32x16_bf16 v[128:143], v[40:43], v[56:59], v[128:143]
    v_mfma_f32_32x32x16_bf16 v[144:159], v[40:43], v[60:63], v[144:159]
    ds_read_b64_tr_b16 v[40:41], v16 offset:24576
    ds_read_b64_tr_b16 v[42:43], v16 offset:25600
    s_waitcnt lgkmcnt(8)
    v_mfma_f32_32x32x16_bf16 v[160:175], v[44:47], v[56:59], v[160:175]
    v_mfma_f32_32x32x16_bf16 v[176:191], v[44:47], v[60:63], v[176:191]
    ds_read_b64_tr_b16 v[44:45], v17 offset:24576
    ds_read_b64_tr_b16 v[46:47], v17 offset:25600
    ds_read_b128 v[56:59], v21 offset:24576
    ds_read_b128 v[60:63], v21 offset:26624
    s_waitcnt lgkmcnt(8)
    v_mfma_f32_32x32x16_bf16 v[64:79], v[32:35], v[48:51], v[64:79]
    v_mfma_f32_32x32x16_bf16 v[80:95], v[32:35], v[52:55], v[80:95]
    ds_read_b64_tr_b16 v[32:33], v14 offset:28672
    ds_read_b64_tr_b16 v[34:35], v14 offset:29696
    s_waitcnt lgkmcnt(8)
    v_mfma_f32_32x32x16_bf16 v[96:111], v[36:39], v[48:51], v[96:111]
    v_mfma_f32_32x32x16_bf16 v[112:127], v[36:39], v[52:55], v[112:127]
    ds_read_b64_tr_b16 v[36:37], v15 offset:28672
    ds_read_b64_tr_b16 v[38:39], v15 offset:29696
    s_waitcnt lgkmcnt(8)
    v_mfma_f32_32x32x16_bf16 v[128:143], v[40:43], v[48:51], v[128:143]
    v_mfma_f32_32x32x16_bf16 v[144:159], v[40:43], v[52:55], v[144:159]
    ds_read_b64_tr_b16 v[40:41], v16 offset:28672
    ds_read_b64_tr_b16 v[42:43], v16 offset:29696
    s_waitcnt lgkmcnt(8)
    v_mfma_f32_32x32x16_bf16 v[160:175], v[44:47], v[48:51], v[160:175]
    v_mfma_f32_32x32x16_bf16 v[176:191], v[44:47], v[52:55], v[176:191]
    ds_read_b64_tr_b16 v[44:45], v17 offset:28672
    ds_read_b64_tr_b16 v[46:47], v17 offset:29696
    s_barrier
    ds_read_b128 v[48:51], v18 offset:0
    ds_read_b128 v[52:55], v18 offset:2048
    s_waitcnt lgkmcnt(8)
    v_mfma_f32_32x32x16_bf16 v[64:79], v[32:35], v[56:59], v[64:79]
    v_mfma_f32_32x32x16_bf16 v[80:95], v[32:35], v[60:63], v[80:95]
    ds_read_b64_tr_b16 v[32:33], v10 offset:0
    ds_read_b64_tr_b16 v[34:35], v10 offset:1024
    s_waitcnt lgkmcnt(8)
    v_mfma_f32_32x32x16_bf16 v[96:111], v[36:39], v[56:59], v[96:111]
    v_mfma_f32_32x32x16_bf16 v[112:127], v[36:39], v[60:63], v[112:127]
    ds_read_b64_tr_b16 v[36:37], v11 offset:0
    ds_read_b64_tr_b16 v[38:39], v11 offset:1024
    s_waitcnt lgkmcnt(8)
    v_mfma_f32_32x32x16_bf16 v[128:143], v[40:43], v[56:59], v[128:143]
    v_mfma_f32_32x32x16_bf16 v[144:159], v[40:43], v[60:63], v[144:159]
    ds_read_b64_tr_b16 v[40:41], v12 offset:0
    ds_read_b64_tr_b16 v[42:43], v12 offset:1024
    s_waitcnt lgkmcnt(8)
    v_mfma_f32_32x32x16_bf16 v[160:175], v[44:47], v[56:59], v[160:175]
    v_mfma_f32_32x32x16_bf16 v[176:191], v[44:47], v[60:63], v[176:191]
    ds_read_b64_tr_b16 v[44:45], v13 offset:0
    ds_read_b64_tr_b16 v[46:47], v13 offset:1024
    ds_read_b128 v[56:59], v19 offset:0
    ds_read_b128 v[60:63], v19 offset:2048
    s_waitcnt lgkmcnt(8)
    v_mfma_f32_32x32x16_bf16 v[64:79], v[32:35], v[48:51], v[64:79]
    v_mfma_f32_32x32x16_bf16 v[80:95], v[32:35], v[52:55], v[80:95]
    ds_read_b64_tr_b16 v[32:33], v10 offset:4096
    ds_read_b64_tr_b16 v[34:35], v10 offset:5120
    s_waitcnt lgkmcnt(8)
    v_mfma_f32_32x32x16_bf16 v[96:111], v[36:39], v[48:51], v[96:111]
    v_mfma_f32_32x32x16_bf16 v[112:127], v[36:39], v[52:55], v[112:127]
    ds_read_b64_tr_b16 v[36:37], v11 offset:4096
    ds_read_b64_tr_b16 v[38:39], v11 offset:5120
    s_waitcnt lgkmcnt(8)
    v_mfma_f32_32x32x16_bf16 v[128:143], v[40:43], v[48:51], v[128:143]
    v_mfma_f32_32x32x16_bf16 v[144:159], v[40:43], v[52:55], v[144:159]
    ds_read_b64_tr_b16 v[40:41], v12 offset:4096
    ds_read_b64_tr_b16 v[42:43], v12 offset:5120
    s_waitcnt lgkmcnt(8)
    v_mfma_f32_32x32x16_bf16 v[160:175], v[44:47], v[48:51], v[160:175]
    v_mfma_f32_32x32x16_bf16 v[176:191], v[44:47], v[52:55], v[176:191]
    ds_read_b64_tr_b16 v[44:45], v13 offset:4096
    ds_read_b64_tr_b16 v[46:47], v13 offset:5120
    s_barrier
    ds_read_b128 v[48:51], v26 offset:0
    ds_read_b128 v[52:55], v26 offset:2048
    s_waitcnt lgkmcnt(8)
    v_mfma_f32_32x32x16_bf16 v[64:79], v[32:35], v[56:59], v[64:79]
    v_mfma_f32_32x32x16_bf16 v[80:95], v[32:35], v[60:63], v[80:95]
    ds_read_b64_tr_b16 v[32:33], v22 offset:0
    ds_read_b64_tr_b16 v[34:35], v22 offset:1024
    s_waitcnt lgkmcnt(8)
    v_mfma_f32_32x32x16_bf16 v[96:111], v[36:39], v[56:59], v[96:111]
    v_mfma_f32_32x32x16_bf16 v[112:127], v[36:39], v[60:63], v[112:127]
    ds_read_b64_tr_b16 v[36:37], v23 offset:0
    ds_read_b64_tr_b16 v[38:39], v23 offset:1024
    s_waitcnt lgkmcnt(8)
    v_mfma_f32_32x32x16_bf16 v[128:143], v[40:43], v[56:59], v[128:143]
    v_mfma_f32_32x32x16_bf16 v[144:159], v[40:43], v[60:63], v[144:159]
    ds_read_b64_tr_b16 v[40:41], v24 offset:0
    ds_read_b64_tr_b16 v[42:43], v24 offset:1024
    s_waitcnt lgkmcnt(8)
    v_mfma_f32_32x32x16_bf16 v[160:175], v[44:47], v[56:59], v[160:175]
    v_mfma_f32_32x32x16_bf16 v[176:191], v[44:47], v[60:63], v[176:191]
    ds_read_b64_tr_b16 v[44:45], v25 offset:0
    ds_read_b64_tr_b16 v[46:47], v25 offset:1024
    ds_read_b128 v[56:59], v27 offset:0
    ds_read_b128 v[60:63], v27 offset:2048
    s_waitcnt lgkmcnt(8)
    v_mfma_f32_32x32x16_bf16 v[64:79], v[32:35], v[48:51], v[64:79]
    v_mfma_f32_32x32x16_bf16 v[80:95], v[32:35], v[52:55], v[80:95]
    ds_read_b64_tr_b16 v[32:33], v22 offset:4096
    ds_read_b64_tr_b16 v[34:35], v22 offset:5120
    s_waitcnt lgkmcnt(8)
    v_mfma_f32_32x32x16_bf16 v[96:111], v[36:39], v[48:51], v[96:111]
    v_mfma_f32_32x32x16_bf16 v[112:127], v[36:39], v[52:55], v[112:127]
    ds_read_b64_tr_b16 v[36:37], v23 offset:4096
    ds_read_b64_tr_b16 v[38:39], v23 offset:5120
    s_waitcnt lgkmcnt(8)
    v_mfma_f32_32x32x16_bf16 v[128:143], v[40:43], v[48:51], v[128:143]
    v_mfma_f32_32x32x16_bf16 v[144:159], v[40:43], v[52:55], v[144:159]
    ds_read_b64_tr_b16 v[40:41], v24 offset:4096
    ds_read_b64_tr_b16 v[42:43], v24 offset:5120
    s_waitcnt lgkmcnt(8)
    v_mfma_f32_32x32x16_bf16 v[160:175], v[44:47], v[48:51], v[160:175]
    v_mfma_f32_32x32x16_bf16 v[176:191], v[44:47], v[52:55], v[176:191]
    ds_read_b64_tr_b16 v[44:45], v25 offset:4096
    ds_read_b64_tr_b16 v[46:47], v25 offset:5120
    s_barrier
    ds_read_b128 v[48:51], v18 offset:24576
    ds_read_b128 v[52:55], v18 offset:26624
    s_waitcnt lgkmcnt(8)
    v_mfma_f32_32x32x16_bf16 v[64:79], v[32:35], v[56:59], v[64:79]
    v_mfma_f32_32x32x16_bf16 v[80:95], v[32:35], v[60:63], v[80:95]
    ds_read_b64_tr_b16 v[32:33], v10 offset:24576
    ds_read_b64_tr_b16 v[34:35], v10 offset:25600
    s_waitcnt lgkmcnt(8)
    v_mfma_f32_32x32x16_bf16 v[96:111], v[36:39], v[56:59], v[96:111]
    v_mfma_f32_32x32x16_bf16 v[112:127], v[36:39], v[60:63], v[112:127]
    ds_read_b64_tr_b16 v[36:37], v11 offset:24576
    ds_read_b64_tr_b16 v[38:39], v11 offset:25600
    s_waitcnt lgkmcnt(8)
    v_mfma_f32_32x32x16_bf16 v[128:143], v[40:43], v[56:59], v[128:143]
    v_mfma_f32_32x32x16_bf16 v[144:159], v[40:43], v[60:63], v[144:159]
    ds_read_b64_tr_b16 v[40:41], v12 offset:24576
    ds_read_b64_tr_b16 v[42:43], v12 offset:25600
    s_waitcnt lgkmcnt(8)
    v_mfma_f32_32x32x16_bf16 v[160:175], v[44:47], v[56:59], v[160:175]
    v_mfma_f32_32x32x16_bf16 v[176:191], v[44:47], v[60:63], v[176:191]
    ds_read_b64_tr_b16 v[44:45], v13 offset:24576
    ds_read_b64_tr_b16 v[46:47], v13 offset:25600
    ds_read_b128 v[56:59], v19 offset:24576
    ds_read_b128 v[60:63], v19 offset:26624
    s_waitcnt lgkmcnt(8)
    v_mfma_f32_32x32x16_bf16 v[64:79], v[32:35], v[48:51], v[64:79]
    v_mfma_f32_32x32x16_bf16 v[80:95], v[32:35], v[52:55], v[80:95]
    ds_read_b64_tr_b16 v[32:33], v10 offset:28672
    ds_read_b64_tr_b16 v[34:35], v10 offset:29696
    s_waitcnt lgkmcnt(8)
    v_mfma_f32_32x32x16_bf16 v[96:111], v[36:39], v[48:51], v[96:111]
    v_mfma_f32_32x32x16_bf16 v[112:127], v[36:39], v[52:55], v[112:127]
    ds_read_b64_tr_b16 v[36:37], v11 offset:28672
    ds_read_b64_tr_b16 v[38:39], v11 offset:29696
    s_waitcnt lgkmcnt(8)
    v_mfma_f32_32x32x16_bf16 v[128:143], v[40:43], v[48:51], v[128:143]
    v_mfma_f32_32x32x16_bf16 v[144:159], v[40:43], v[52:55], v[144:159]
    ds_read_b64_tr_b16 v[40:41], v12 offset:28672
    ds_read_b64_tr_b16 v[42:43], v12 offset:29696
    s_waitcnt lgkmcnt(8)
    v_mfma_f32_32x32x16_bf16 v[160:175], v[44:47], v[48:51], v[160:175]
    v_mfma_f32_32x32x16_bf16 v[176:191], v[44:47], v[52:55], v[176:191]
    ds_read_b64_tr_b16 v[44:45], v13 offset:28672
    ds_read_b64_tr_b16 v[46:47], v13 offset:29696
    s_barrier
    ds_read_b128 v[48:51], v18 offset:49152
    ds_read_b128 v[52:55], v18 offset:51200
    s_waitcnt lgkmcnt(8)
    v_mfma_f32_32x32x16_bf16 v[64:79], v[32:35], v[56:59], v[64:79]
    v_mfma_f32_32x32x16_bf16 v[80:95], v[32:35], v[60:63], v[80:95]
    ds_read_b64_tr_b16 v[32:33], v10 offset:49152
    ds_read_b64_tr_b16 v[34:35], v10 offset:50176
    s_waitcnt lgkmcnt(8)
    v_mfma_f32_32x32x16_bf16 v[96:111], v[36:39], v[56:59], v[96:111]
    v_mfma_f32_32x32x16_bf16 v[112:127], v[36:39], v[60:63], v[112:127]
    ds_read_b64_tr_b16 v[36:37], v11 offset:49152
    ds_read_b64_tr_b16 v[38:39], v11 offset:50176
    s_waitcnt lgkmcnt(8)
    v_mfma_f32_32x32x16_bf16 v[128:143], v[40:43], v[56:59], v[128:143]
    v_mfma_f32_32x32x16_bf16 v[144:159], v[40:43], v[60:63], v[144:159]
    ds_read_b64_tr_b16 v[40:41], v12 offset:49152
    ds_read_b64_tr_b16 v[42:43], v12 offset:50176
    s_waitcnt lgkmcnt(8)
    v_mfma_f32_32x32x16_bf16 v[160:175], v[44:47], v[56:59], v[160:175]
    v_mfma_f32_32x32x16_bf16 v[176:191], v[44:47], v[60:63], v[176:191]
    ds_read_b64_tr_b16 v[44:45], v13 offset:49152
    ds_read_b64_tr_b16 v[46:47], v13 offset:50176
    ds_read_b128 v[56:59], v19 offset:49152
    ds_read_b128 v[60:63], v19 offset:51200
    s_waitcnt lgkmcnt(8)
    v_mfma_f32_32x32x16_bf16 v[64:79], v[32:35], v[48:51], v[64:79]
    v_mfma_f32_32x32x16_bf16 v[80:95], v[32:35], v[52:55], v[80:95]
    ds_read_b64_tr_b16 v[32:33], v10 offset:53248
    ds_read_b64_tr_b16 v[34:35], v10 offset:54272
    s_waitcnt lgkmcnt(8)
    v_mfma_f32_32x32x16_bf16 v[96:111], v[36:39], v[48:51], v[96:111]
    v_mfma_f32_32x32x16_bf16 v[112:127], v[36:39], v[52:55], v[112:127]
    ds_read_b64_tr_b16 v[36:37], v11 offset:53248
    ds_read_b64_tr_b16 v[38:39], v11 offset:54272
    s_waitcnt lgkmcnt(8)
    v_mfma_f32_32x32x16_bf16 v[128:143], v[40:43], v[48:51], v[128:143]
    v_mfma_f32_32x32x16_bf16 v[144:159], v[40:43], v[52:55], v[144:159]
    ds_read_b64_tr_b16 v[40:41], v12 offset:53248
    ds_read_b64_tr_b16 v[42:43], v12 offset:54272
    s_waitcnt lgkmcnt(8)
    v_mfma_f32_32x32x16_bf16 v[160:175], v[44:47], v[48:51], v[160:175]
    v_mfma_f32_32x32x16_bf16 v[176:191], v[44:47], v[52:55], v[176:191]
    ds_read_b64_tr_b16 v[44:45], v13 offset:53248
    ds_read_b64_tr_b16 v[46:47], v13 offset:54272
    s_barrier
    ds_read_b128 v[48:51], v20 offset:0
    ds_read_b128 v[52:55], v20 offset:2048
    s_waitcnt lgkmcnt(8)
    v_mfma_f32_32x32x16_bf16 v[64:79], v[32:35], v[56:59], v[64:79]
    v_mfma_f32_32x32x16_bf16 v[80:95], v[32:35], v[60:63], v[80:95]
    ds_read_b64_tr_b16 v[32:33], v14 offset:0
    ds_read_b64_tr_b16 v[34:35], v14 offset:1024
    s_waitcnt lgkmcnt(8)
    v_mfma_f32_32x32x16_bf16 v[96:111], v[36:39], v[56:59], v[96:111]
    v_mfma_f32_32x32x16_bf16 v[112:127], v[36:39], v[60:63], v[112:127]
    ds_read_b64_tr_b16 v[36:37], v15 offset:0
    ds_read_b64_tr_b16 v[38:39], v15 offset:1024
    s_waitcnt lgkmcnt(8)
    v_mfma_f32_32x32x16_bf16 v[128:143], v[40:43], v[56:59], v[128:143]
    v_mfma_f32_32x32x16_bf16 v[144:159], v[40:43], v[60:63], v[144:159]
    ds_read_b64_tr_b16 v[40:41], v16 offset:0
    ds_read_b64_tr_b16 v[42:43], v16 offset:1024
    s_waitcnt lgkmcnt(8)
    v_mfma_f32_32x32x16_bf16 v[160:175], v[44:47], v[56:59], v[160:175]
    v_mfma_f32_32x32x16_bf16 v[176:191], v[44:47], v[60:63], v[176:191]
    ds_read_b64_tr_b16 v[44:45], v17 offset:0
    ds_read_b64_tr_b16 v[46:47], v17 offset:1024
    ds_read_b128 v[56:59], v21 offset:0
    ds_read_b128 v[60:63], v21 offset:2048
    s_waitcnt lgkmcnt(8)
    v_mfma_f32_32x32x16_bf16 v[64:79], v[32:35], v[48:51], v[64:79]
    v_mfma_f32_32x32x16_bf16 v[80:95], v[32:35], v[52:55], v[80:95]
    ds_read_b64_tr_b16 v[32:33], v14 offset:4096
    ds_read_b64_tr_b16 v[34:35], v14 offset:5120
    s_waitcnt lgkmcnt(8)
    v_mfma_f32_32x32x16_bf16 v[96:111], v[36:39], v[48:51], v[96:111]
    v_mfma_f32_32x32x16_bf16 v[112:127], v[36:39], v[52:55], v[112:127]
    ds_read_b64_tr_b16 v[36:37], v15 offset:4096
    ds_read_b64_tr_b16 v[38:39], v15 offset:5120
    s_waitcnt lgkmcnt(8)
    v_mfma_f32_32x32x16_bf16 v[128:143], v[40:43], v[48:51], v[128:143]
    v_mfma_f32_32x32x16_bf16 v[144:159], v[40:43], v[52:55], v[144:159]
    ds_read_b64_tr_b16 v[40:41], v16 offset:4096
    ds_read_b64_tr_b16 v[42:43], v16 offset:5120
    s_waitcnt lgkmcnt(8)
    v_mfma_f32_32x32x16_bf16 v[160:175], v[44:47], v[48:51], v[160:175]
    v_mfma_f32_32x32x16_bf16 v[176:191], v[44:47], v[52:55], v[176:191]
    ds_read_b64_tr_b16 v[44:45], v17 offset:4096
    ds_read_b64_tr_b16 v[46:47], v17 offset:5120
    s_barrier
    ds_read_b128 v[48:51], v20 offset:24576
    ds_read_b128 v[52:55], v20 offset:26624
    s_waitcnt lgkmcnt(8)
    v_mfma_f32_32x32x16_bf16 v[64:79], v[32:35], v[56:59], v[64:79]
    v_mfma_f32_32x32x16_bf16 v[80:95], v[32:35], v[60:63], v[80:95]
    ds_read_b64_tr_b16 v[32:33], v14 offset:24576
    ds_read_b64_tr_b16 v[34:35], v14 offset:25600
    s_waitcnt lgkmcnt(8)
    v_mfma_f32_32x32x16_bf16 v[96:111], v[36:39], v[56:59], v[96:111]
    v_mfma_f32_32x32x16_bf16 v[112:127], v[36:39], v[60:63], v[112:127]
    ds_read_b64_tr_b16 v[36:37], v15 offset:24576
    ds_read_b64_tr_b16 v[38:39], v15 offset:25600
    s_waitcnt lgkmcnt(8)
    v_mfma_f32_32x32x16_bf16 v[128:143], v[40:43], v[56:59], v[128:143]
    v_mfma_f32_32x32x16_bf16 v[144:159], v[40:43], v[60:63], v[144:159]
    ds_read_b64_tr_b16 v[40:41], v16 offset:24576
    ds_read_b64_tr_b16 v[42:43], v16 offset:25600
    s_waitcnt lgkmcnt(8)
    v_mfma_f32_32x32x16_bf16 v[160:175], v[44:47], v[56:59], v[160:175]
    v_mfma_f32_32x32x16_bf16 v[176:191], v[44:47], v[60:63], v[176:191]
    ds_read_b64_tr_b16 v[44:45], v17 offset:24576
    ds_read_b64_tr_b16 v[46:47], v17 offset:25600
    ds_read_b128 v[56:59], v21 offset:24576
    ds_read_b128 v[60:63], v21 offset:26624
    s_waitcnt lgkmcnt(8)
    v_mfma_f32_32x32x16_bf16 v[64:79], v[32:35], v[48:51], v[64:79]
    v_mfma_f32_32x32x16_bf16 v[80:95], v[32:35], v[52:55], v[80:95]
    ds_read_b64_tr_b16 v[32:33], v14 offset:28672
    ds_read_b64_tr_b16 v[34:35], v14 offset:29696
    s_waitcnt lgkmcnt(8)
    v_mfma_f32_32x32x16_bf16 v[96:111], v[36:39], v[48:51], v[96:111]
    v_mfma_f32_32x32x16_bf16 v[112:127], v[36:39], v[52:55], v[112:127]
    ds_read_b64_tr_b16 v[36:37], v15 offset:28672
    ds_read_b64_tr_b16 v[38:39], v15 offset:29696
    s_waitcnt lgkmcnt(8)
    v_mfma_f32_32x32x16_bf16 v[128:143], v[40:43], v[48:51], v[128:143]
    v_mfma_f32_32x32x16_bf16 v[144:159], v[40:43], v[52:55], v[144:159]
    ds_read_b64_tr_b16 v[40:41], v16 offset:28672
    ds_read_b64_tr_b16 v[42:43], v16 offset:29696
    s_waitcnt lgkmcnt(8)
    v_mfma_f32_32x32x16_bf16 v[160:175], v[44:47], v[48:51], v[160:175]
    v_mfma_f32_32x32x16_bf16 v[176:191], v[44:47], v[52:55], v[176:191]
    ds_read_b64_tr_b16 v[44:45], v17 offset:28672
    ds_read_b64_tr_b16 v[46:47], v17 offset:29696
    s_barrier
    ds_read_b128 v[48:51], v18 offset:0
    ds_read_b128 v[52:55], v18 offset:2048
    s_waitcnt lgkmcnt(8)
    v_mfma_f32_32x32x16_bf16 v[64:79], v[32:35], v[56:59], v[64:79]
    v_mfma_f32_32x32x16_bf16 v[80:95], v[32:35], v[60:63], v[80:95]
    ds_read_b64_tr_b16 v[32:33], v10 offset:0
    ds_read_b64_tr_b16 v[34:35], v10 offset:1024
    s_waitcnt lgkmcnt(8)
    v_mfma_f32_32x32x16_bf16 v[96:111], v[36:39], v[56:59], v[96:111]
    v_mfma_f32_32x32x16_bf16 v[112:127], v[36:39], v[60:63], v[112:127]
    ds_read_b64_tr_b16 v[36:37], v11 offset:0
    ds_read_b64_tr_b16 v[38:39], v11 offset:1024
    s_waitcnt lgkmcnt(8)
    v_mfma_f32_32x32x16_bf16 v[128:143], v[40:43], v[56:59], v[128:143]
    v_mfma_f32_32x32x16_bf16 v[144:159], v[40:43], v[60:63], v[144:159]
    ds_read_b64_tr_b16 v[40:41], v12 offset:0
    ds_read_b64_tr_b16 v[42:43], v12 offset:1024
    s_waitcnt lgkmcnt(8)
    v_mfma_f32_32x32x16_bf16 v[160:175], v[44:47], v[56:59], v[160:175]
    v_mfma_f32_32x32x16_bf16 v[176:191], v[44:47], v[60:63], v[176:191]
    ds_read_b64_tr_b16 v[44:45], v13 offset:0
    ds_read_b64_tr_b16 v[46:47], v13 offset:1024
    ds_read_b128 v[56:59], v19 offset:0
    ds_read_b128 v[60:63], v19 offset:2048
    s_waitcnt lgkmcnt(8)
    v_mfma_f32_32x32x16_bf16 v[64:79], v[32:35], v[48:51], v[64:79]
    v_mfma_f32_32x32x16_bf16 v[80:95], v[32:35], v[52:55], v[80:95]
    ds_read_b64_tr_b16 v[32:33], v10 offset:4096
    ds_read_b64_tr_b16 v[34:35], v10 offset:5120
    s_waitcnt lgkmcnt(8)
    v_mfma_f32_32x32x16_bf16 v[96:111], v[36:39], v[48:51], v[96:111]
    v_mfma_f32_32x32x16_bf16 v[112:127], v[36:39], v[52:55], v[112:127]
    ds_read_b64_tr_b16 v[36:37], v11 offset:4096
    ds_read_b64_tr_b16 v[38:39], v11 offset:5120
    s_waitcnt lgkmcnt(8)
    v_mfma_f32_32x32x16_bf16 v[128:143], v[40:43], v[48:51], v[128:143]
    v_mfma_f32_32x32x16_bf16 v[144:159], v[40:43], v[52:55], v[144:159]
    ds_read_b64_tr_b16 v[40:41], v12 offset:4096
    ds_read_b64_tr_b16 v[42:43], v12 offset:5120
    s_waitcnt lgkmcnt(8)
    v_mfma_f32_32x32x16_bf16 v[160:175], v[44:47], v[48:51], v[160:175]
    v_mfma_f32_32x32x16_bf16 v[176:191], v[44:47], v[52:55], v[176:191]
    ds_read_b64_tr_b16 v[44:45], v13 offset:4096
    ds_read_b64_tr_b16 v[46:47], v13 offset:5120
    s_barrier
    ds_read_b128 v[48:51], v26 offset:0
    ds_read_b128 v[52:55], v26 offset:2048
    s_waitcnt lgkmcnt(8)
    v_mfma_f32_32x32x16_bf16 v[64:79], v[32:35], v[56:59], v[64:79]
    v_mfma_f32_32x32x16_bf16 v[80:95], v[32:35], v[60:63], v[80:95]
    ds_read_b64_tr_b16 v[32:33], v22 offset:0
    ds_read_b64_tr_b16 v[34:35], v22 offset:1024
    s_waitcnt lgkmcnt(8)
    v_mfma_f32_32x32x16_bf16 v[96:111], v[36:39], v[56:59], v[96:111]
    v_mfma_f32_32x32x16_bf16 v[112:127], v[36:39], v[60:63], v[112:127]
    ds_read_b64_tr_b16 v[36:37], v23 offset:0
    ds_read_b64_tr_b16 v[38:39], v23 offset:1024
    s_waitcnt lgkmcnt(8)
    v_mfma_f32_32x32x16_bf16 v[128:143], v[40:43], v[56:59], v[128:143]
    v_mfma_f32_32x32x16_bf16 v[144:159], v[40:43], v[60:63], v[144:159]
    ds_read_b64_tr_b16 v[40:41], v24 offset:0
    ds_read_b64_tr_b16 v[42:43], v24 offset:1024
    s_waitcnt lgkmcnt(8)
    v_mfma_f32_32x32x16_bf16 v[160:175], v[44:47], v[56:59], v[160:175]
    v_mfma_f32_32x32x16_bf16 v[176:191], v[44:47], v[60:63], v[176:191]
    ds_read_b64_tr_b16 v[44:45], v25 offset:0
    ds_read_b64_tr_b16 v[46:47], v25 offset:1024
    ds_read_b128 v[56:59], v27 offset:0
    ds_read_b128 v[60:63], v27 offset:2048
    s_waitcnt lgkmcnt(8)
    v_mfma_f32_32x32x16_bf16 v[64:79], v[32:35], v[48:51], v[64:79]
    v_mfma_f32_32x32x16_bf16 v[80:95], v[32:35], v[52:55], v[80:95]
    ds_read_b64_tr_b16 v[32:33], v22 offset:4096
    ds_read_b64_tr_b16 v[34:35], v22 offset:5120
    s_waitcnt lgkmcnt(8)
    v_mfma_f32_32x32x16_bf16 v[96:111], v[36:39], v[48:51], v[96:111]
    v_mfma_f32_32x32x16_bf16 v[112:127], v[36:39], v[52:55], v[112:127]
    ds_read_b64_tr_b16 v[36:37], v23 offset:4096
    ds_read_b64_tr_b16 v[38:39], v23 offset:5120
    s_waitcnt lgkmcnt(8)
    v_mfma_f32_32x32x16_bf16 v[128:143], v[40:43], v[48:51], v[128:143]
    v_mfma_f32_32x32x16_bf16 v[144:159], v[40:43], v[52:55], v[144:159]
    ds_read_b64_tr_b16 v[40:41], v24 offset:4096
    ds_read_b64_tr_b16 v[42:43], v24 offset:5120
    s_waitcnt lgkmcnt(8)
    v_mfma_f32_32x32x16_bf16 v[160:175], v[44:47], v[48:51], v[160:175]
    v_mfma_f32_32x32x16_bf16 v[176:191], v[44:47], v[52:55], v[176:191]
    ds_read_b64_tr_b16 v[44:45], v25 offset:4096
    ds_read_b64_tr_b16 v[46:47], v25 offset:5120
    s_barrier
    ds_read_b128 v[48:51], v18 offset:24576
    ds_read_b128 v[52:55], v18 offset:26624
    s_waitcnt lgkmcnt(8)
    v_mfma_f32_32x32x16_bf16 v[64:79], v[32:35], v[56:59], v[64:79]
    v_mfma_f32_32x32x16_bf16 v[80:95], v[32:35], v[60:63], v[80:95]
    ds_read_b64_tr_b16 v[32:33], v10 offset:24576
    ds_read_b64_tr_b16 v[34:35], v10 offset:25600
    s_waitcnt lgkmcnt(8)
    v_mfma_f32_32x32x16_bf16 v[96:111], v[36:39], v[56:59], v[96:111]
    v_mfma_f32_32x32x16_bf16 v[112:127], v[36:39], v[60:63], v[112:127]
    ds_read_b64_tr_b16 v[36:37], v11 offset:24576
    ds_read_b64_tr_b16 v[38:39], v11 offset:25600
    s_waitcnt lgkmcnt(8)
    v_mfma_f32_32x32x16_bf16 v[128:143], v[40:43], v[56:59], v[128:143]
    v_mfma_f32_32x32x16_bf16 v[144:159], v[40:43], v[60:63], v[144:159]
    ds_read_b64_tr_b16 v[40:41], v12 offset:24576
    ds_read_b64_tr_b16 v[42:43], v12 offset:25600
    s_waitcnt lgkmcnt(8)
    v_mfma_f32_32x32x16_bf16 v[160:175], v[44:47], v[56:59], v[160:175]
    v_mfma_f32_32x32x16_bf16 v[176:191], v[44:47], v[60:63], v[176:191]
    ds_read_b64_tr_b16 v[44:45], v13 offset:24576
    ds_read_b64_tr_b16 v[46:47], v13 offset:25600
    ds_read_b128 v[56:59], v19 offset:24576
    ds_read_b128 v[60:63], v19 offset:26624
    s_waitcnt lgkmcnt(8)
    v_mfma_f32_32x32x16_bf16 v[64:79], v[32:35], v[48:51], v[64:79]
    v_mfma_f32_32x32x16_bf16 v[80:95], v[32:35], v[52:55], v[80:95]
    ds_read_b64_tr_b16 v[32:33], v10 offset:28672
    ds_read_b64_tr_b16 v[34:35], v10 offset:29696
    s_waitcnt lgkmcnt(8)
    v_mfma_f32_32x32x16_bf16 v[96:111], v[36:39], v[48:51], v[96:111]
    v_mfma_f32_32x32x16_bf16 v[112:127], v[36:39], v[52:55], v[112:127]
    ds_read_b64_tr_b16 v[36:37], v11 offset:28672
    ds_read_b64_tr_b16 v[38:39], v11 offset:29696
    s_waitcnt lgkmcnt(8)
    v_mfma_f32_32x32x16_bf16 v[128:143], v[40:43], v[48:51], v[128:143]
    v_mfma_f32_32x32x16_bf16 v[144:159], v[40:43], v[52:55], v[144:159]
    ds_read_b64_tr_b16 v[40:41], v12 offset:28672
    ds_read_b64_tr_b16 v[42:43], v12 offset:29696
    s_waitcnt lgkmcnt(8)
    v_mfma_f32_32x32x16_bf16 v[160:175], v[44:47], v[48:51], v[160:175]
    v_mfma_f32_32x32x16_bf16 v[176:191], v[44:47], v[52:55], v[176:191]
    ds_read_b64_tr_b16 v[44:45], v13 offset:28672
    ds_read_b64_tr_b16 v[46:47], v13 offset:29696
    s_barrier
    ds_read_b128 v[48:51], v18 offset:49152
    ds_read_b128 v[52:55], v18 offset:51200
    s_waitcnt lgkmcnt(8)
    v_mfma_f32_32x32x16_bf16 v[64:79], v[32:35], v[56:59], v[64:79]
    v_mfma_f32_32x32x16_bf16 v[80:95], v[32:35], v[60:63], v[80:95]
    ds_read_b64_tr_b16 v[32:33], v10 offset:49152
    ds_read_b64_tr_b16 v[34:35], v10 offset:50176
    s_waitcnt lgkmcnt(8)
    v_mfma_f32_32x32x16_bf16 v[96:111], v[36:39], v[56:59], v[96:111]
    v_mfma_f32_32x32x16_bf16 v[112:127], v[36:39], v[60:63], v[112:127]
    ds_read_b64_tr_b16 v[36:37], v11 offset:49152
    ds_read_b64_tr_b16 v[38:39], v11 offset:50176
    s_waitcnt lgkmcnt(8)
    v_mfma_f32_32x32x16_bf16 v[128:143], v[40:43], v[56:59], v[128:143]
    v_mfma_f32_32x32x16_bf16 v[144:159], v[40:43], v[60:63], v[144:159]
    ds_read_b64_tr_b16 v[40:41], v12 offset:49152
    ds_read_b64_tr_b16 v[42:43], v12 offset:50176
    s_waitcnt lgkmcnt(8)
    v_mfma_f32_32x32x16_bf16 v[160:175], v[44:47], v[56:59], v[160:175]
    v_mfma_f32_32x32x16_bf16 v[176:191], v[44:47], v[60:63], v[176:191]
    ds_read_b64_tr_b16 v[44:45], v13 offset:49152
    ds_read_b64_tr_b16 v[46:47], v13 offset:50176
    ds_read_b128 v[56:59], v19 offset:49152
    ds_read_b128 v[60:63], v19 offset:51200
    s_waitcnt lgkmcnt(8)
    v_mfma_f32_32x32x16_bf16 v[64:79], v[32:35], v[48:51], v[64:79]
    v_mfma_f32_32x32x16_bf16 v[80:95], v[32:35], v[52:55], v[80:95]
    ds_read_b64_tr_b16 v[32:33], v10 offset:53248
    ds_read_b64_tr_b16 v[34:35], v10 offset:54272
    s_waitcnt lgkmcnt(8)
    v_mfma_f32_32x32x16_bf16 v[96:111], v[36:39], v[48:51], v[96:111]
    v_mfma_f32_32x32x16_bf16 v[112:127], v[36:39], v[52:55], v[112:127]
    ds_read_b64_tr_b16 v[36:37], v11 offset:53248
    ds_read_b64_tr_b16 v[38:39], v11 offset:54272
    s_waitcnt lgkmcnt(8)
    v_mfma_f32_32x32x16_bf16 v[128:143], v[40:43], v[48:51], v[128:143]
    v_mfma_f32_32x32x16_bf16 v[144:159], v[40:43], v[52:55], v[144:159]
    ds_read_b64_tr_b16 v[40:41], v12 offset:53248
    ds_read_b64_tr_b16 v[42:43], v12 offset:54272
    s_waitcnt lgkmcnt(8)
    v_mfma_f32_32x32x16_bf16 v[160:175], v[44:47], v[48:51], v[160:175]
    v_mfma_f32_32x32x16_bf16 v[176:191], v[44:47], v[52:55], v[176:191]
    ds_read_b64_tr_b16 v[44:45], v13 offset:53248
    ds_read_b64_tr_b16 v[46:47], v13 offset:54272
    s_barrier
    ds_read_b128 v[48:51], v20 offset:0
    ds_read_b128 v[52:55], v20 offset:2048
    s_waitcnt lgkmcnt(8)
    v_mfma_f32_32x32x16_bf16 v[64:79], v[32:35], v[56:59], v[64:79]
    v_mfma_f32_32x32x16_bf16 v[80:95], v[32:35], v[60:63], v[80:95]
    ds_read_b64_tr_b16 v[208:209], v14 offset:0
    ds_read_b64_tr_b16 v[210:211], v14 offset:1024
    s_waitcnt lgkmcnt(8)
    v_mfma_f32_32x32x16_bf16 v[96:111], v[36:39], v[56:59], v[96:111]
    v_mfma_f32_32x32x16_bf16 v[112:127], v[36:39], v[60:63], v[112:127]
    ds_read_b64_tr_b16 v[212:213], v14 offset:4096
    ds_read_b64_tr_b16 v[214:215], v14 offset:5120
    s_waitcnt lgkmcnt(8)
    v_mfma_f32_32x32x16_bf16 v[128:143], v[40:43], v[56:59], v[128:143]
    v_mfma_f32_32x32x16_bf16 v[144:159], v[40:43], v[60:63], v[144:159]
    s_waitcnt lgkmcnt(6)
    v_mfma_f32_32x32x16_bf16 v[160:175], v[44:47], v[56:59], v[160:175]
    v_mfma_f32_32x32x16_bf16 v[176:191], v[44:47], v[60:63], v[176:191]
    s_barrier
    ds_read_b128 v[56:59], v21 offset:0
    ds_read_b128 v[60:63], v21 offset:2048
    ds_read_b64_tr_b16 v[216:217], v14 offset:24576
    ds_read_b64_tr_b16 v[218:219], v14 offset:25600
    ds_read_b128 v[192:195], v20 offset:24576
    ds_read_b128 v[196:199], v20 offset:26624
    ds_read_b64_tr_b16 v[220:221], v14 offset:28672
    ds_read_b64_tr_b16 v[222:223], v14 offset:29696
    ds_read_b128 v[200:203], v21 offset:24576
    ds_read_b128 v[204:207], v21 offset:26624
    ds_read_b32 v30, v30
    s_setprio 2
    s_waitcnt lgkmcnt(13)
    v_mfma_f32_32x32x16_bf16 v[64:79], v[208:211], v[48:51], v[64:79]
    ds_read_b64_tr_b16 v[224:225], v15 offset:0
    ds_read_b64_tr_b16 v[226:227], v15 offset:1024
    v_mfma_f32_32x32x16_bf16 v[80:95], v[208:211], v[52:55], v[80:95]
    s_waitcnt lgkmcnt(11)
    v_mfma_f32_32x32x16_bf16 v[64:79], v[212:215], v[56:59], v[64:79]
    ds_read_b64_tr_b16 v[228:229], v15 offset:4096
    ds_read_b64_tr_b16 v[230:231], v15 offset:5120
    v_mfma_f32_32x32x16_bf16 v[80:95], v[212:215], v[60:63], v[80:95]
    s_waitcnt lgkmcnt(9)
    v_mfma_f32_32x32x16_bf16 v[64:79], v[216:219], v[192:195], v[64:79]
    ds_read_b64_tr_b16 v[232:233], v15 offset:24576
    ds_read_b64_tr_b16 v[234:235], v15 offset:25600
    v_mfma_f32_32x32x16_bf16 v[80:95], v[216:219], v[196:199], v[80:95]
    s_waitcnt lgkmcnt(7)
    v_mfma_f32_32x32x16_bf16 v[64:79], v[220:223], v[200:203], v[64:79]
    ds_read_b64_tr_b16 v[236:237], v15 offset:28672
    ds_read_b64_tr_b16 v[238:239], v15 offset:29696
    v_mfma_f32_32x32x16_bf16 v[80:95], v[220:223], v[204:207], v[80:95]
    s_waitcnt lgkmcnt(6)
    v_mfma_f32_32x32x16_bf16 v[96:111], v[224:227], v[48:51], v[96:111]
    ds_read_b64_tr_b16 v[208:209], v16 offset:0
    ds_read_b64_tr_b16 v[210:211], v16 offset:1024
    s_nop 9
    v_mfma_f32_32x32x16_bf16 v[112:127], v[224:227], v[52:55], v[112:127]
    v_mul_f32 v32, 0x3fb8aa3b, v64
    v_mul_f32 v33, 0x3fb8aa3b, v65
    v_mul_f32 v34, 0x3fb8aa3b, v66
    v_mul_f32 v35, 0x3fb8aa3b, v67
    v_mul_f32 v36, 0x3fb8aa3b, v68
    v_mul_f32 v37, 0x3fb8aa3b, v69
    v_mul_f32 v38, 0x3fb8aa3b, v70
    v_mul_f32 v39, 0x3fb8aa3b, v71
    v_exp_f32 v32, -v32
    v_exp_f32 v33, -v33
    v_exp_f32 v34, -v34
    v_exp_f32 v35, -v35
    v_exp_f32 v36, -v36
    v_exp_f32 v37, -v37
    v_exp_f32 v38, -v38
    v_exp_f32 v39, -v39
    s_waitcnt lgkmcnt(6)
    v_mfma_f32_32x32x16_bf16 v[96:111], v[228:231], v[56:59], v[96:111]
    ds_read_b64_tr_b16 v[212:213], v16 offset:4096
    ds_read_b64_tr_b16 v[214:215], v16 offset:5120
    v_mul_f32 v64, v64, v72
    v_mul_f32 v65, v65, v73
    v_mul_f32 v66, v66, v74
    v_mul_f32 v67, v67, v75
    v_mul_f32 v68, v68, v76
    v_mul_f32 v69, v69, v77
    v_mul_f32 v70, v70, v78
    v_mul_f32 v71, v71, v79
    v_add_f32 v32, 1.0, v32
    v_add_f32 v33, 1.0, v33
    v_add_f32 v34, 1.0, v34
    v_add_f32 v35, 1.0, v35
    v_add_f32 v36, 1.0, v36
    v_add_f32 v37, 1.0, v37
    v_add_f32 v38, 1.0, v38
    v_add_f32 v39, 1.0, v39
    v_mfma_f32_32x32x16_bf16 v[112:127], v[228:231], v[60:63], v[112:127]
    v_rcp_f32 v32, v32
    v_rcp_f32 v33, v33
    v_rcp_f32 v34, v34
    v_rcp_f32 v35, v35
    v_rcp_f32 v36, v36
    v_rcp_f32 v37, v37
    v_rcp_f32 v38, v38
    v_rcp_f32 v39, v39
    s_nop 0
    v_mul_f32 v64, v64, v32
    v_mul_f32 v65, v65, v33
    v_mul_f32 v66, v66, v34
    v_mul_f32 v67, v67, v35
    v_mul_f32 v68, v68, v36
    v_mul_f32 v69, v69, v37
    v_mul_f32 v70, v70, v38
    s_waitcnt lgkmcnt(6)
    v_mfma_f32_32x32x16_bf16 v[96:111], v[232:235], v[192:195], v[96:111]
    ds_read_b64_tr_b16 v[216:217], v16 offset:24576
    ds_read_b64_tr_b16 v[218:219], v16 offset:25600
    v_mul_f32 v71, v71, v39
    v_cvt_pk_bf16_f32 v72, v64, v65
    v_cvt_pk_bf16_f32 v73, v66, v67
    v_cvt_pk_bf16_f32 v74, v68, v69
    v_cvt_pk_bf16_f32 v75, v70, v71
    buffer_store_dwordx4 v[72:75], v8, s[60:63], s78 offen offset:0 sc1
    v_mul_f32 v40, 0x3fb8aa3b, v80
    v_mul_f32 v41, 0x3fb8aa3b, v81
    v_mul_f32 v42, 0x3fb8aa3b, v82
    v_mul_f32 v43, 0x3fb8aa3b, v83
    v_mul_f32 v44, 0x3fb8aa3b, v84
    v_mul_f32 v45, 0x3fb8aa3b, v85
    v_mul_f32 v46, 0x3fb8aa3b, v86
    v_mul_f32 v47, 0x3fb8aa3b, v87
    v_exp_f32 v40, -v40
    v_exp_f32 v41, -v41
    v_mfma_f32_32x32x16_bf16 v[112:127], v[232:235], v[196:199], v[112:127]
    v_exp_f32 v42, -v42
    v_exp_f32 v43, -v43
    v_exp_f32 v44, -v44
    v_exp_f32 v45, -v45
    v_exp_f32 v46, -v46
    v_exp_f32 v47, -v47
    v_mul_f32 v80, v80, v88
    v_mul_f32 v81, v81, v89
    v_mul_f32 v82, v82, v90
    v_mul_f32 v83, v83, v91
    v_mul_f32 v84, v84, v92
    v_mul_f32 v85, v85, v93
    v_mul_f32 v86, v86, v94
    v_mul_f32 v87, v87, v95
    v_add_f32 v40, 1.0, v40
    v_add_f32 v41, 1.0, v41
    s_waitcnt lgkmcnt(6)
    v_mfma_f32_32x32x16_bf16 v[96:111], v[236:239], v[200:203], v[96:111]
    ds_read_b64_tr_b16 v[220:221], v16 offset:28672
    ds_read_b64_tr_b16 v[222:223], v16 offset:29696
    v_add_f32 v42, 1.0, v42
    v_add_f32 v43, 1.0, v43
    v_add_f32 v44, 1.0, v44
    v_add_f32 v45, 1.0, v45
    v_add_f32 v46, 1.0, v46
    v_add_f32 v47, 1.0, v47
    v_rcp_f32 v40, v40
    v_rcp_f32 v41, v41
    v_rcp_f32 v42, v42
    v_rcp_f32 v43, v43
    v_rcp_f32 v44, v44
    v_rcp_f32 v45, v45
    v_rcp_f32 v46, v46
    v_rcp_f32 v47, v47
    s_nop 0
    v_mul_f32 v80, v80, v40
    v_mfma_f32_32x32x16_bf16 v[112:127], v[236:239], v[204:207], v[112:127]
    v_mul_f32 v81, v81, v41
    v_mul_f32 v82, v82, v42
    v_mul_f32 v83, v83, v43
    v_mul_f32 v84, v84, v44
    v_mul_f32 v85, v85, v45
    v_mul_f32 v86, v86, v46
    v_mul_f32 v87, v87, v47
    v_cvt_pk_bf16_f32 v88, v80, v81
    v_cvt_pk_bf16_f32 v89, v82, v83
    v_cvt_pk_bf16_f32 v90, v84, v85
    v_cvt_pk_bf16_f32 v91, v86, v87
    buffer_store_dwordx4 v[88:91], v8, s[60:63], s79 offen offset:0 sc1
    s_waitcnt lgkmcnt(6)
    v_mfma_f32_32x32x16_bf16 v[128:143], v[208:211], v[48:51], v[128:143]
    ds_read_b64_tr_b16 v[224:225], v17 offset:0
    ds_read_b64_tr_b16 v[226:227], v17 offset:1024
    s_nop 9
    v_mfma_f32_32x32x16_bf16 v[144:159], v[208:211], v[52:55], v[144:159]
    v_mul_f32 v32, 0x3fb8aa3b, v96
    v_mul_f32 v33, 0x3fb8aa3b, v97
    v_mul_f32 v34, 0x3fb8aa3b, v98
    v_mul_f32 v35, 0x3fb8aa3b, v99
    v_mul_f32 v36, 0x3fb8aa3b, v100
    v_mul_f32 v37, 0x3fb8aa3b, v101
    v_mul_f32 v38, 0x3fb8aa3b, v102
    v_mul_f32 v39, 0x3fb8aa3b, v103
    v_exp_f32 v32, -v32
    v_exp_f32 v33, -v33
    v_exp_f32 v34, -v34
    v_exp_f32 v35, -v35
    v_exp_f32 v36, -v36
    v_exp_f32 v37, -v37
    v_exp_f32 v38, -v38
    v_exp_f32 v39, -v39
    s_waitcnt lgkmcnt(6)
    v_mfma_f32_32x32x16_bf16 v[128:143], v[212:215], v[56:59], v[128:143]
    ds_read_b64_tr_b16 v[228:229], v17 offset:4096
    ds_read_b64_tr_b16 v[230:231], v17 offset:5120
    v_mul_f32 v96, v96, v104
    v_mul_f32 v97, v97, v105
    v_mul_f32 v98, v98, v106
    v_mul_f32 v99, v99, v107
    v_mul_f32 v100, v100, v108
    v_mul_f32 v101, v101, v109
    v_mul_f32 v102, v102, v110
    v_mul_f32 v103, v103, v111
    v_add_f32 v32, 1.0, v32
    v_add_f32 v33, 1.0, v33
    v_add_f32 v34, 1.0, v34
    v_add_f32 v35, 1.0, v35
    v_add_f32 v36, 1.0, v36
    v_add_f32 v37, 1.0, v37
    v_add_f32 v38, 1.0, v38
    v_add_f32 v39, 1.0, v39
    v_mfma_f32_32x32x16_bf16 v[144:159], v[212:215], v[60:63], v[144:159]
    v_rcp_f32 v32, v32
    v_rcp_f32 v33, v33
    v_rcp_f32 v34, v34
    v_rcp_f32 v35, v35
    v_rcp_f32 v36, v36
    v_rcp_f32 v37, v37
    v_rcp_f32 v38, v38
    v_rcp_f32 v39, v39
    s_nop 0
    v_mul_f32 v96, v96, v32
    v_mul_f32 v97, v97, v33
    v_mul_f32 v98, v98, v34
    v_mul_f32 v99, v99, v35
    v_mul_f32 v100, v100, v36
    v_mul_f32 v101, v101, v37
    v_mul_f32 v102, v102, v38
    s_waitcnt lgkmcnt(6)
    v_mfma_f32_32x32x16_bf16 v[128:143], v[216:219], v[192:195], v[128:143]
    ds_read_b64_tr_b16 v[232:233], v17 offset:24576
    ds_read_b64_tr_b16 v[234:235], v17 offset:25600
    v_mul_f32 v103, v103, v39
    v_cvt_pk_bf16_f32 v104, v96, v97
    v_cvt_pk_bf16_f32 v105, v98, v99
    v_cvt_pk_bf16_f32 v106, v100, v101
    v_cvt_pk_bf16_f32 v107, v102, v103
    buffer_store_dwordx4 v[104:107], v8, s[60:63], s78 offen offset:1024 sc1
    v_mul_f32 v40, 0x3fb8aa3b, v112
    v_mul_f32 v41, 0x3fb8aa3b, v113
    v_mul_f32 v42, 0x3fb8aa3b, v114
    v_mul_f32 v43, 0x3fb8aa3b, v115
    v_mul_f32 v44, 0x3fb8aa3b, v116
    v_mul_f32 v45, 0x3fb8aa3b, v117
    v_mul_f32 v46, 0x3fb8aa3b, v118
    v_mul_f32 v47, 0x3fb8aa3b, v119
    v_exp_f32 v40, -v40
    v_exp_f32 v41, -v41
    v_mfma_f32_32x32x16_bf16 v[144:159], v[216:219], v[196:199], v[144:159]
    v_exp_f32 v42, -v42
    v_exp_f32 v43, -v43
    v_exp_f32 v44, -v44
    v_exp_f32 v45, -v45
    v_exp_f32 v46, -v46
    v_exp_f32 v47, -v47
    v_mul_f32 v112, v112, v120
    v_mul_f32 v113, v113, v121
    v_mul_f32 v114, v114, v122
    v_mul_f32 v115, v115, v123
    v_mul_f32 v116, v116, v124
    v_mul_f32 v117, v117, v125
    v_mul_f32 v118, v118, v126
    v_mul_f32 v119, v119, v127
    v_add_f32 v40, 1.0, v40
    v_add_f32 v41, 1.0, v41
    s_waitcnt lgkmcnt(6)
    v_mfma_f32_32x32x16_bf16 v[128:143], v[220:223], v[200:203], v[128:143]
    ds_read_b64_tr_b16 v[236:237], v17 offset:28672
    ds_read_b64_tr_b16 v[238:239], v17 offset:29696
    v_add_f32 v42, 1.0, v42
    v_add_f32 v43, 1.0, v43
    v_add_f32 v44, 1.0, v44
    v_add_f32 v45, 1.0, v45
    v_add_f32 v46, 1.0, v46
    v_add_f32 v47, 1.0, v47
    v_rcp_f32 v40, v40
    v_rcp_f32 v41, v41
    v_rcp_f32 v42, v42
    v_rcp_f32 v43, v43
    v_rcp_f32 v44, v44
    v_rcp_f32 v45, v45
    v_rcp_f32 v46, v46
    v_rcp_f32 v47, v47
    s_nop 0
    v_mul_f32 v112, v112, v40
    v_mfma_f32_32x32x16_bf16 v[144:159], v[220:223], v[204:207], v[144:159]
    v_mul_f32 v113, v113, v41
    v_mul_f32 v114, v114, v42
    v_mul_f32 v115, v115, v43
    v_mul_f32 v116, v116, v44
    v_mul_f32 v117, v117, v45
    v_mul_f32 v118, v118, v46
    v_mul_f32 v119, v119, v47
    v_cvt_pk_bf16_f32 v120, v112, v113
    v_cvt_pk_bf16_f32 v121, v114, v115
    v_cvt_pk_bf16_f32 v122, v116, v117
    v_cvt_pk_bf16_f32 v123, v118, v119
    buffer_store_dwordx4 v[120:123], v8, s[60:63], s79 offen offset:1024 sc1
    s_waitcnt lgkmcnt(6)
    v_mfma_f32_32x32x16_bf16 v[160:175], v[224:227], v[48:51], v[160:175]
    s_nop 9
    v_mfma_f32_32x32x16_bf16 v[176:191], v[224:227], v[52:55], v[176:191]
    v_mul_f32 v32, 0x3fb8aa3b, v128
    v_mul_f32 v33, 0x3fb8aa3b, v129
    v_mul_f32 v34, 0x3fb8aa3b, v130
    v_mul_f32 v35, 0x3fb8aa3b, v131
    v_mul_f32 v36, 0x3fb8aa3b, v132
    v_mul_f32 v37, 0x3fb8aa3b, v133
    v_mul_f32 v38, 0x3fb8aa3b, v134
    v_mul_f32 v39, 0x3fb8aa3b, v135
    v_exp_f32 v32, -v32
    v_exp_f32 v33, -v33
    v_exp_f32 v34, -v34
    v_exp_f32 v35, -v35
    v_exp_f32 v36, -v36
    v_exp_f32 v37, -v37
    v_exp_f32 v38, -v38
    v_exp_f32 v39, -v39
    s_waitcnt lgkmcnt(0)
    ds_write_b32 v28, v29
    v_mfma_f32_32x32x16_bf16 v[160:175], v[228:231], v[56:59], v[160:175]
    v_mul_f32 v128, v128, v136
    v_mul_f32 v129, v129, v137
    v_mul_f32 v130, v130, v138
    v_mul_f32 v131, v131, v139
    v_mul_f32 v132, v132, v140
    v_mul_f32 v133, v133, v141
    v_mul_f32 v134, v134, v142
    v_mul_f32 v135, v135, v143
    v_add_f32 v32, 1.0, v32
    v_add_f32 v33, 1.0, v33
    v_add_f32 v34, 1.0, v34
    v_add_f32 v35, 1.0, v35
    v_add_f32 v36, 1.0, v36
    v_add_f32 v37, 1.0, v37
    v_add_f32 v38, 1.0, v38
    v_add_f32 v39, 1.0, v39
    v_mfma_f32_32x32x16_bf16 v[176:191], v[228:231], v[60:63], v[176:191]
    v_rcp_f32 v32, v32
    v_rcp_f32 v33, v33
    v_rcp_f32 v34, v34
    v_rcp_f32 v35, v35
    v_rcp_f32 v36, v36
    v_rcp_f32 v37, v37
    v_rcp_f32 v38, v38
    v_rcp_f32 v39, v39
    s_nop 0
    v_mul_f32 v128, v128, v32
    v_mul_f32 v129, v129, v33
    v_mul_f32 v130, v130, v34
    v_mul_f32 v131, v131, v35
    v_mul_f32 v132, v132, v36
    v_mul_f32 v133, v133, v37
    v_mul_f32 v134, v134, v38
    v_mfma_f32_32x32x16_bf16 v[160:175], v[232:235], v[192:195], v[160:175]
    v_mul_f32 v135, v135, v39
    v_cvt_pk_bf16_f32 v136, v128, v129
    v_cvt_pk_bf16_f32 v137, v130, v131
    v_cvt_pk_bf16_f32 v138, v132, v133
    v_cvt_pk_bf16_f32 v139, v134, v135
    buffer_store_dwordx4 v[136:139], v8, s[60:63], s78 offen offset:2048 sc1
    v_mul_f32 v40, 0x3fb8aa3b, v144
    v_mul_f32 v41, 0x3fb8aa3b, v145
    v_mul_f32 v42, 0x3fb8aa3b, v146
    v_mul_f32 v43, 0x3fb8aa3b, v147
    v_mul_f32 v44, 0x3fb8aa3b, v148
    v_mul_f32 v45, 0x3fb8aa3b, v149
    v_mul_f32 v46, 0x3fb8aa3b, v150
    v_mul_f32 v47, 0x3fb8aa3b, v151
    v_exp_f32 v40, -v40
    v_exp_f32 v41, -v41
    v_mfma_f32_32x32x16_bf16 v[176:191], v[232:235], v[196:199], v[176:191]
    v_exp_f32 v42, -v42
    v_exp_f32 v43, -v43
    v_exp_f32 v44, -v44
    v_exp_f32 v45, -v45
    v_exp_f32 v46, -v46
    v_exp_f32 v47, -v47
    v_mul_f32 v144, v144, v152
    v_mul_f32 v145, v145, v153
    v_mul_f32 v146, v146, v154
    v_mul_f32 v147, v147, v155
    v_mul_f32 v148, v148, v156
    v_mul_f32 v149, v149, v157
    v_mul_f32 v150, v150, v158
    v_mul_f32 v151, v151, v159
    v_add_f32 v40, 1.0, v40
    v_add_f32 v41, 1.0, v41
    v_mfma_f32_32x32x16_bf16 v[160:175], v[236:239], v[200:203], v[160:175]
    v_add_f32 v42, 1.0, v42
    v_add_f32 v43, 1.0, v43
    v_add_f32 v44, 1.0, v44
    v_add_f32 v45, 1.0, v45
    v_add_f32 v46, 1.0, v46
    v_add_f32 v47, 1.0, v47
    v_rcp_f32 v40, v40
    v_rcp_f32 v41, v41
    v_rcp_f32 v42, v42
    v_rcp_f32 v43, v43
    v_rcp_f32 v44, v44
    v_rcp_f32 v45, v45
    v_rcp_f32 v46, v46
    v_rcp_f32 v47, v47
    s_nop 0
    v_mul_f32 v144, v144, v40
    v_mfma_f32_32x32x16_bf16 v[176:191], v[236:239], v[204:207], v[176:191]
    v_mul_f32 v145, v145, v41
    v_mul_f32 v146, v146, v42
    v_mul_f32 v147, v147, v43
    v_mul_f32 v148, v148, v44
    v_mul_f32 v149, v149, v45
    v_mul_f32 v150, v150, v46
    v_mul_f32 v151, v151, v47
    v_cvt_pk_bf16_f32 v152, v144, v145
    v_cvt_pk_bf16_f32 v153, v146, v147
    v_cvt_pk_bf16_f32 v154, v148, v149
    v_cvt_pk_bf16_f32 v155, v150, v151
    buffer_store_dwordx4 v[152:155], v8, s[60:63], s79 offen offset:2048 sc1
    s_nop 9
    v_mul_f32 v32, 0x3fb8aa3b, v160
    v_mul_f32 v33, 0x3fb8aa3b, v161
    v_mul_f32 v34, 0x3fb8aa3b, v162
    v_mul_f32 v35, 0x3fb8aa3b, v163
    v_mul_f32 v36, 0x3fb8aa3b, v164
    v_mul_f32 v37, 0x3fb8aa3b, v165
    v_mul_f32 v38, 0x3fb8aa3b, v166
    v_mul_f32 v39, 0x3fb8aa3b, v167
    v_exp_f32 v32, -v32
    v_exp_f32 v33, -v33
    v_exp_f32 v34, -v34
    v_exp_f32 v35, -v35
    v_exp_f32 v36, -v36
    v_exp_f32 v37, -v37
    v_exp_f32 v38, -v38
    v_exp_f32 v39, -v39
    v_mul_f32 v160, v160, v168
    v_mul_f32 v161, v161, v169
    v_mul_f32 v162, v162, v170
    v_mul_f32 v163, v163, v171
    v_mul_f32 v164, v164, v172
    v_mul_f32 v165, v165, v173
    v_mul_f32 v166, v166, v174
    v_mul_f32 v167, v167, v175
    v_add_f32 v32, 1.0, v32
    v_add_f32 v33, 1.0, v33
    v_add_f32 v34, 1.0, v34
    v_add_f32 v35, 1.0, v35
    v_add_f32 v36, 1.0, v36
    v_add_f32 v37, 1.0, v37
    v_add_f32 v38, 1.0, v38
    v_add_f32 v39, 1.0, v39
    v_rcp_f32 v32, v32
    v_rcp_f32 v33, v33
    v_rcp_f32 v34, v34
    v_rcp_f32 v35, v35
    v_rcp_f32 v36, v36
    v_rcp_f32 v37, v37
    v_rcp_f32 v38, v38
    v_rcp_f32 v39, v39
    s_nop 0
    v_mul_f32 v160, v160, v32
    v_mul_f32 v161, v161, v33
    v_mul_f32 v162, v162, v34
    v_mul_f32 v163, v163, v35
    v_mul_f32 v164, v164, v36
    v_mul_f32 v165, v165, v37
    v_mul_f32 v166, v166, v38
    v_mul_f32 v167, v167, v39
    v_cvt_pk_bf16_f32 v168, v160, v161
    v_cvt_pk_bf16_f32 v169, v162, v163
    v_cvt_pk_bf16_f32 v170, v164, v165
    v_cvt_pk_bf16_f32 v171, v166, v167
    buffer_store_dwordx4 v[168:171], v8, s[60:63], s78 offen offset:3072 sc1
    v_mul_f32 v40, 0x3fb8aa3b, v176
    v_mul_f32 v41, 0x3fb8aa3b, v177
    v_mul_f32 v42, 0x3fb8aa3b, v178
    v_mul_f32 v43, 0x3fb8aa3b, v179
    v_mul_f32 v44, 0x3fb8aa3b, v180
    v_mul_f32 v45, 0x3fb8aa3b, v181
    v_mul_f32 v46, 0x3fb8aa3b, v182
    v_mul_f32 v47, 0x3fb8aa3b, v183
    v_exp_f32 v40, -v40
    v_exp_f32 v41, -v41
    v_exp_f32 v42, -v42
    v_exp_f32 v43, -v43
    v_exp_f32 v44, -v44
    v_exp_f32 v45, -v45
    v_exp_f32 v46, -v46
    v_exp_f32 v47, -v47
    v_mul_f32 v176, v176, v184
    v_mul_f32 v177, v177, v185
    v_mul_f32 v178, v178, v186
    v_mul_f32 v179, v179, v187
    v_mul_f32 v180, v180, v188
    v_mul_f32 v181, v181, v189
    v_mul_f32 v182, v182, v190
    v_mul_f32 v183, v183, v191
    v_add_f32 v40, 1.0, v40
    v_add_f32 v41, 1.0, v41
    v_add_f32 v42, 1.0, v42
    v_add_f32 v43, 1.0, v43
    v_add_f32 v44, 1.0, v44
    v_add_f32 v45, 1.0, v45
    v_add_f32 v46, 1.0, v46
    v_add_f32 v47, 1.0, v47
    v_rcp_f32 v40, v40
    v_rcp_f32 v41, v41
    v_rcp_f32 v42, v42
    v_rcp_f32 v43, v43
    v_rcp_f32 v44, v44
    v_rcp_f32 v45, v45
    v_rcp_f32 v46, v46
    v_rcp_f32 v47, v47
    s_nop 0
    v_mul_f32 v176, v176, v40
    v_mul_f32 v177, v177, v41
    v_mul_f32 v178, v178, v42
    v_mul_f32 v179, v179, v43
    v_mul_f32 v180, v180, v44
    v_mul_f32 v181, v181, v45
    v_mul_f32 v182, v182, v46
    v_mul_f32 v183, v183, v47
    v_cvt_pk_bf16_f32 v184, v176, v177
    v_cvt_pk_bf16_f32 v185, v178, v179
    v_cvt_pk_bf16_f32 v186, v180, v181
    v_cvt_pk_bf16_f32 v187, v182, v183
    buffer_store_dwordx4 v[184:187], v8, s[60:63], s79 offen offset:3072 sc1
    v_mov_b32 v28, 64
    s_mov_b32 s47, 0
L_mr_1:
    ds_read_b128 v[24:27], v28
    s_waitcnt lgkmcnt(0)
    v_and_b32 v24, v24, v25
    v_and_b32 v26, v26, v27
    v_and_b32 v24, v24, v26
    s_nop 0
    v_readfirstlane_b32 s70, v24
    s_cmp_eq_u32 s70, 1
    s_cselect_b32 s47, 1048576, s47
    s_add_u32 s47, s47, 1
    s_cmp_lt_u32 s47, 1048576
    s_cbranch_scc1 L_mr_1
    v_readfirstlane_b32 s46, v30
    s_add_u32 m0, s66, 49152
    s_mov_b32 s67, 98304
    buffer_load_dwordx4 v2, s[52:55], s67 offen lds
    s_add_u32 m0, s66, 50176
    s_mov_b32 s67, 106496
    buffer_load_dwordx4 v2, s[52:55], s67 offen lds
    s_add_u32 m0, s66, 51200
    s_mov_b32 s67, 114688
    buffer_load_dwordx4 v2, s[52:55], s67 offen lds
    s_add_u32 m0, s66, 52224
    s_mov_b32 s67, 122880
    buffer_load_dwordx4 v2, s[52:55], s67 offen lds
    s_add_u32 m0, s66, 53248
    s_mov_b32 s67, 131072
    buffer_load_dwordx4 v2, s[52:55], s67 offen lds
    s_add_u32 m0, s66, 54272
    s_mov_b32 s67, 139264
    buffer_load_dwordx4 v2, s[52:55], s67 offen lds
    s_lshl_b32 s71, s45, 4
    v_mov_b32 v24, s71
    s_waitcnt vmcnt(6)
    v_mov_b32 v22, s46
    v_lshlrev_b32 v23, 2, v1
    s_mov_b32 exec_hi, 0
    buffer_store_dword v22, v23, s[60:63], s81 offen sc1
    s_mov_b32 exec_hi, -1
    s_mov_b32 s47, 0
L_lw_2:
    ds_read_b32 v25, v24 offset:12
    s_waitcnt lgkmcnt(0)
    v_readfirstlane_b32 s70, v25
    s_cmp_eq_u32 s70, 1
    s_cselect_b32 s47, 1048576, s47
    s_add_u32 s47, s47, 1
    s_cmp_lt_u32 s47, 1048576
    s_cbranch_scc1 L_lw_2
L_G2:
    ds_read_b64_tr_b16 v[88:89], v6 offset:0
    ds_read_b64_tr_b16 v[90:91], v6 offset:1024
    ds_read_b64_tr_b16 v[92:93], v7 offset:0
    ds_read_b64_tr_b16 v[94:95], v7 offset:1024
    ds_read_b64_tr_b16 v[96:97], v6 offset:2048
    ds_read_b64_tr_b16 v[98:99], v6 offset:3072
    ds_read_b64_tr_b16 v[100:101], v7 offset:2048
    ds_read_b64_tr_b16 v[102:103], v7 offset:3072
    ds_read_b64_tr_b16 v[104:105], v6 offset:4096
    ds_read_b64_tr_b16 v[106:107], v6 offset:5120
    ds_read_b64_tr_b16 v[108:109], v7 offset:4096
    ds_read_b64_tr_b16 v[110:111], v7 offset:5120
    ds_read_b64_tr_b16 v[112:113], v6 offset:24576
    ds_read_b64_tr_b16 v[114:115], v6 offset:25600
    ds_read_b64_tr_b16 v[116:117], v7 offset:24576
    ds_read_b64_tr_b16 v[118:119], v7 offset:25600
    ds_read_b64_tr_b16 v[120:121], v6 offset:26624
    ds_read_b64_tr_b16 v[122:123], v6 offset:27648
    ds_read_b64_tr_b16 v[124:125], v7 offset:26624
    ds_read_b64_tr_b16 v[126:127], v7 offset:27648
    ds_read_b64_tr_b16 v[128:129], v6 offset:28672
    ds_read_b64_tr_b16 v[130:131], v6 offset:29696
    ds_read_b64_tr_b16 v[132:133], v7 offset:28672
    ds_read_b64_tr_b16 v[134:135], v7 offset:29696
    v_min_u32 v9, 6, v1
    v_lshlrev_b32 v9, 7, v9
    s_lshl_b32 s82, s43, 5
    s_mul_i32 s69, s45, 7
    s_add_u32 s82, s82, s69
    s_lshl_b32 s82, s82, 7
    s_add_u32 s82, s82, 12648448
    s_mul_i32 s68, s43, 224
    s_lshl_b32 s69, s69, 2
    s_add_u32 s68, s68, s69
    s_lshl_b32 s68, s68, 10
    s_mul_i32 s69, s85, 114688
    s_sub_u32 s70, 114688, s69
    s_add_u32 s69, s68, s69
    s_add_u32 s68, s68, s70
    s_waitcnt lgkmcnt(15)
    s_add_u32 m0, s66, 0
    s_mov_b32 s67, 147456
    buffer_load_dwordx4 v2, s[52:55], s67 offen lds
    s_add_u32 m0, s66, 1024
    s_mov_b32 s67, 155648
    buffer_load_dwordx4 v2, s[52:55], s67 offen lds
    s_add_u32 m0, s66, 2048
    s_mov_b32 s67, 163840
    buffer_load_dwordx4 v2, s[52:55], s67 offen lds
    s_add_u32 m0, s66, 3072
    s_mov_b32 s67, 172032
    buffer_load_dwordx4 v2, s[52:55], s67 offen lds
    s_waitcnt lgkmcnt(12)
    s_add_u32 m0, s66, 4096
    s_mov_b32 s67, 180224
    buffer_load_dwordx4 v2, s[52:55], s67 offen lds
    s_add_u32 m0, s66, 5120
    s_mov_b32 s67, 188416
    buffer_load_dwordx4 v2, s[52:55], s67 offen lds
    s_waitcnt lgkmcnt(8)
    s_add_u32 m0, s66, 24576
    s_mov_b32 s67, 196608
    buffer_load_dwordx4 v2, s[52:55], s67 offen lds
    s_add_u32 m0, s66, 25600
    s_mov_b32 s67, 204800
    buffer_load_dwordx4 v2, s[52:55], s67 offen lds
    s_waitcnt lgkmcnt(4)
    s_add_u32 m0, s66, 26624
    s_mov_b32 s67, 212992
    buffer_load_dwordx4 v2, s[52:55], s67 offen lds
    s_add_u32 m0, s66, 27648
    s_mov_b32 s67, 221184
    buffer_load_dwordx4 v2, s[52:55], s67 offen lds
    s_waitcnt vmcnt(15)
    ds_read_b64_tr_b16 v[136:137], v6 offset:49152
    ds_read_b64_tr_b16 v[138:139], v6 offset:50176
    ds_read_b64_tr_b16 v[140:141], v7 offset:49152
    ds_read_b64_tr_b16 v[142:143], v7 offset:50176
    s_waitcnt lgkmcnt(4)
    s_add_u32 m0, s66, 28672
    s_mov_b32 s67, 229376
    buffer_load_dwordx4 v2, s[52:55], s67 offen lds
    s_add_u32 m0, s66, 29696
    s_mov_b32 s67, 237568
    buffer_load_dwordx4 v2, s[52:55], s67 offen lds
    s_waitcnt vmcnt(15)
    ds_read_b64_tr_b16 v[144:145], v6 offset:51200
    ds_read_b64_tr_b16 v[146:147], v6 offset:52224
    ds_read_b64_tr_b16 v[148:149], v7 offset:51200
    ds_read_b64_tr_b16 v[150:151], v7 offset:52224
    s_waitcnt lgkmcnt(4)
    s_add_u32 m0, s66, 49152
    s_mov_b32 s67, 245760
    buffer_load_dwordx4 v2, s[52:55], s67 offen lds
    s_add_u32 m0, s66, 50176
    s_mov_b32 s67, 253952
    buffer_load_dwordx4 v2, s[52:55], s67 offen lds
    s_waitcnt vmcnt(15)
    ds_read_b64_tr_b16 v[152:153], v6 offset:53248
    ds_read_b64_tr_b16 v[154:155], v6 offset:54272
    ds_read_b64_tr_b16 v[156:157], v7 offset:53248
    ds_read_b64_tr_b16 v[158:159], v7 offset:54272
    s_waitcnt lgkmcnt(4)
    s_add_u32 m0, s66, 51200
    s_mov_b32 s67, 262144
    buffer_load_dwordx4 v2, s[52:55], s67 offen lds
    s_add_u32 m0, s66, 52224
    s_mov_b32 s67, 270336
    buffer_load_dwordx4 v2, s[52:55], s67 offen lds
    s_waitcnt vmcnt(14)
    ds_read_b64_tr_b16 v[160:161], v6 offset:0
    ds_read_b64_tr_b16 v[162:163], v6 offset:1024
    ds_read_b64_tr_b16 v[164:165], v7 offset:0
    ds_read_b64_tr_b16 v[166:167], v7 offset:1024
    s_waitcnt lgkmcnt(4)
    s_add_u32 m0, s66, 53248
    s_mov_b32 s67, 278528
    buffer_load_dwordx4 v2, s[52:55], s67 offen lds
    s_add_u32 m0, s66, 54272
    s_mov_b32 s67, 286720
    buffer_load_dwordx4 v2, s[52:55], s67 offen lds
    buffer_load_dword v10, v9, s[60:63], s82 offen sc1
    s_waitcnt vmcnt(15)
    ds_read_b64_tr_b16 v[168:169], v6 offset:2048
    ds_read_b64_tr_b16 v[170:171], v6 offset:3072
    ds_read_b64_tr_b16 v[172:173], v7 offset:2048
    ds_read_b64_tr_b16 v[174:175], v7 offset:3072
    s_waitcnt lgkmcnt(4)
    s_add_u32 m0, s66, 0
    s_mov_b32 s67, 294912
    buffer_load_dwordx4 v2, s[52:55], s67 offen lds
    s_add_u32 m0, s66, 1024
    s_mov_b32 s67, 303104
    buffer_load_dwordx4 v2, s[52:55], s67 offen lds
    s_waitcnt vmcnt(2)
    v_cmp_eq_u32 vcc, s46, v10
    s_nop 0
    s_mov_b32 s83, vcc_lo
    s_bitcmp1_b32 s83, 0
    s_cbranch_scc0 L_cold_3
L_back_4:
    buffer_load_dwordx4 v[176:179], v8, s[60:63], s69 offen offset:0 sc1
    buffer_load_dwordx4 v[180:183], v8, s[60:63], s68 offen offset:0 sc1
    buffer_load_dwordx4 v[184:187], v8, s[60:63], s69 offen offset:1024 sc1
    buffer_load_dwordx4 v[188:191], v8, s[60:63], s68 offen offset:1024 sc1
    buffer_load_dwordx4 v[192:195], v8, s[60:63], s69 offen offset:2048 sc1
    buffer_load_dwordx4 v[196:199], v8, s[60:63], s68 offen offset:2048 sc1
    buffer_load_dwordx4 v[200:203], v8, s[60:63], s69 offen offset:3072 sc1
    buffer_load_dwordx4 v[204:207], v8, s[60:63], s68 offen offset:3072 sc1
    s_bitcmp1_b32 s83, 1
    s_cbranch_scc0 L_cold_6
L_back_7:
    s_add_u32 s68, s68, 4096
    s_add_u32 s69, s69, 4096
    buffer_load_dwordx4 v[208:211], v8, s[60:63], s69 offen offset:0 sc1
    buffer_load_dwordx4 v[212:215], v8, s[60:63], s68 offen offset:0 sc1
    buffer_load_dwordx4 v[216:219], v8, s[60:63], s69 offen offset:1024 sc1
    buffer_load_dwordx4 v[220:223], v8, s[60:63], s68 offen offset:1024 sc1
    buffer_load_dwordx4 v[224:227], v8, s[60:63], s69 offen offset:2048 sc1
    buffer_load_dwordx4 v[228:231], v8, s[60:63], s68 offen offset:2048 sc1
    buffer_load_dwordx4 v[232:235], v8, s[60:63], s69 offen offset:3072 sc1
    buffer_load_dwordx4 v[236:239], v8, s[60:63], s68 offen offset:3072 sc1
    s_bitcmp1_b32 s83, 2
    s_cbranch_scc0 L_cold_9
L_back_10:
    s_add_u32 s68, s68, 4096
    s_add_u32 s69, s69, 4096
    buffer_load_dwordx4 v[240:243], v8, s[60:63], s69 offen offset:0 sc1
    buffer_load_dwordx4 v[244:247], v8, s[60:63], s68 offen offset:0 sc1
    buffer_load_dwordx4 v[248:251], v8, s[60:63], s69 offen offset:1024 sc1
    buffer_load_dwordx4 v[252:255], v8, s[60:63], s68 offen offset:1024 sc1
    v_and_b32 v20, 31, v1
    v_lshrrev_b32 v11, 5, v1
    s_lshl_b32 s72, s44, 7
    s_lshr_b32 s73, s43, 4
    s_lshl_b32 s73, s73, 6
    s_add_u32 s72, s72, s73
    s_lshl_b32 s73, s84, 5
    s_add_u32 s72, s72, s73
    s_lshl_b32 s72, s72, 7
    s_add_u32 s72, s72, 294912
    v_lshlrev_b32 v12, 7, v20
    v_add_u32 v12, s72, v12
    s_lshl_b32 s72, s43, 9
    s_add_u32 s72, s72, 278528
    v_and_b32 v13, 3, v1
    v_lshlrev_b32 v13, 7, v13
    v_add_u32 v13, s72, v13
    v_cmp_gt_u32 vcc, 32, v1
    s_nop 1
    v_cndmask_b32 v12, v13, v12, vcc
    s_mov_b32 s76, 12648448
    s_lshl_b32 s72, s43, 6
    s_lshl_b32 s73, s85, 5
    s_add_u32 s72, s72, s73
    s_lshl_b32 s74, s44, 6
    s_lshl_b32 s73, s84, 5
    s_add_u32 s74, s74, s73
    v_add_u32 v21, s72, v20
    v_lshlrev_b32 v15, 2, v21
    v_lshlrev_b32 v16, 1, v21
    v_lshl_add_u32 v16, v11, 14, v16
    s_lshl_b32 s75, s74, 12
    s_add_u32 s75, s75, 10485760
    v_add_u32 v4, s66, v8
    s_xor_b32 s72, s45, 1
    s_mul_i32 s72, s72, 6144
    s_add_u32 s72, s72, 65536
    v_add_u32 v17, s72, v8
    s_xor_b32 s72, s45, 2
    s_mul_i32 s72, s72, 6144
    s_add_u32 s72, s72, 90112
    v_add_u32 v18, s72, v8
    s_xor_b32 s72, s45, 3
    s_mul_i32 s72, s72, 6144
    s_add_u32 s72, s72, 114688
    v_add_u32 v19, s72, v8
    v_lshlrev_b32 v5, 10, v21
    v_lshl_add_u32 v5, v11, 3, v5
    s_lshl_b32 s77, s74, 1
    s_waitcnt vmcnt(18)
    v_mfma_f32_32x32x16_bf16 v[24:39], v[88:91], v[176:179], 0
    v_mfma_f32_32x32x16_bf16 v[40:55], v[88:91], v[180:183], 0
    v_mfma_f32_32x32x16_bf16 v[56:71], v[92:95], v[176:179], 0
    v_mfma_f32_32x32x16_bf16 v[72:87], v[92:95], v[180:183], 0
    buffer_load_dwordx4 v[88:91], v8, s[60:63], s69 offen offset:2048 sc1
    buffer_load_dwordx4 v[92:95], v8, s[60:63], s68 offen offset:2048 sc1
    ds_read_b64_tr_b16 v[176:177], v6 offset:4096
    ds_read_b64_tr_b16 v[178:179], v6 offset:5120
    ds_read_b64_tr_b16 v[180:181], v7 offset:4096
    ds_read_b64_tr_b16 v[182:183], v7 offset:5120
    s_waitcnt lgkmcnt(4)
    s_add_u32 m0, s66, 2048
    s_mov_b32 s67, 311296
    buffer_load_dwordx4 v2, s[52:55], s67 offen lds
    s_add_u32 m0, s66, 3072
    s_mov_b32 s67, 319488
    buffer_load_dwordx4 v2, s[52:55], s67 offen lds
    s_waitcnt vmcnt(20)
    v_mfma_f32_32x32x16_bf16 v[24:39], v[96:99], v[184:187], v[24:39]
    v_mfma_f32_32x32x16_bf16 v[40:55], v[96:99], v[188:191], v[40:55]
    v_mfma_f32_32x32x16_bf16 v[56:71], v[100:103], v[184:187], v[56:71]
    v_mfma_f32_32x32x16_bf16 v[72:87], v[100:103], v[188:191], v[72:87]
    buffer_load_dwordx4 v[96:99], v8, s[60:63], s69 offen offset:3072 sc1
    buffer_load_dwordx4 v[100:103], v8, s[60:63], s68 offen offset:3072 sc1
    ds_read_b64_tr_b16 v[184:185], v6 offset:24576
    ds_read_b64_tr_b16 v[186:187], v6 offset:25600
    ds_read_b64_tr_b16 v[188:189], v7 offset:24576
    ds_read_b64_tr_b16 v[190:191], v7 offset:25600
    s_waitcnt lgkmcnt(4)
    s_add_u32 m0, s66, 4096
    s_mov_b32 s67, 327680
    buffer_load_dwordx4 v2, s[52:55], s67 offen lds
    s_add_u32 m0, s66, 5120
    s_mov_b32 s67, 335872
    buffer_load_dwordx4 v2, s[52:55], s67 offen lds
    s_waitcnt vmcnt(22)
    v_mfma_f32_32x32x16_bf16 v[24:39], v[104:107], v[192:195], v[24:39]
    v_mfma_f32_32x32x16_bf16 v[40:55], v[104:107], v[196:199], v[40:55]
    v_mfma_f32_32x32x16_bf16 v[56:71], v[108:111], v[192:195], v[56:71]
    v_mfma_f32_32x32x16_bf16 v[72:87], v[108:111], v[196:199], v[72:87]
    s_bitcmp1_b32 s83, 3
    s_cbranch_scc0 L_cold_12
L_back_13:
    s_add_u32 s68, s68, 4096
    s_add_u32 s69, s69, 4096
    buffer_load_dwordx4 v[104:107], v8, s[60:63], s69 offen offset:0 sc1
    buffer_load_dwordx4 v[108:111], v8, s[60:63], s68 offen offset:0 sc1
    ds_read_b64_tr_b16 v[192:193], v6 offset:26624
    ds_read_b64_tr_b16 v[194:195], v6 offset:27648
    ds_read_b64_tr_b16 v[196:197], v7 offset:26624
    ds_read_b64_tr_b16 v[198:199], v7 offset:27648
    s_waitcnt lgkmcnt(4)
    s_add_u32 m0, s66, 24576
    s_mov_b32 s67, 344064
    buffer_load_dwordx4 v2, s[52:55], s67 offen lds
    s_add_u32 m0, s66, 25600
    s_mov_b32 s67, 352256
    buffer_load_dwordx4 v2, s[52:55], s67 offen lds
    s_waitcnt vmcnt(24)
    v_mfma_f32_32x32x16_bf16 v[24:39], v[112:115], v[200:203], v[24:39]
    v_mfma_f32_32x32x16_bf16 v[40:55], v[112:115], v[204:207], v[40:55]
    v_mfma_f32_32x32x16_bf16 v[56:71], v[116:119], v[200:203], v[56:71]
    v_mfma_f32_32x32x16_bf16 v[72:87], v[116:119], v[204:207], v[72:87]
    buffer_load_dwordx4 v[112:115], v8, s[60:63], s69 offen offset:1024 sc1
    buffer_load_dwordx4 v[116:119], v8, s[60:63], s68 offen offset:1024 sc1
    ds_read_b64_tr_b16 v[200:201], v6 offset:28672
    ds_read_b64_tr_b16 v[202:203], v6 offset:29696
    ds_read_b64_tr_b16 v[204:205], v7 offset:28672
    ds_read_b64_tr_b16 v[206:207], v7 offset:29696
    s_waitcnt lgkmcnt(4)
    s_add_u32 m0, s66, 26624
    s_mov_b32 s67, 360448
    buffer_load_dwordx4 v2, s[52:55], s67 offen lds
    s_add_u32 m0, s66, 27648
    s_mov_b32 s67, 368640
    buffer_load_dwordx4 v2, s[52:55], s67 offen lds
    s_waitcnt vmcnt(26)
    v_mfma_f32_32x32x16_bf16 v[24:39], v[120:123], v[208:211], v[24:39]
    v_mfma_f32_32x32x16_bf16 v[40:55], v[120:123], v[212:215], v[40:55]
    v_mfma_f32_32x32x16_bf16 v[56:71], v[124:127], v[208:211], v[56:71]
    v_mfma_f32_32x32x16_bf16 v[72:87], v[124:127], v[212:215], v[72:87]
    buffer_load_dwordx4 v[120:123], v8, s[60:63], s69 offen offset:2048 sc1
    buffer_load_dwordx4 v[124:127], v8, s[60:63], s68 offen offset:2048 sc1
    ds_read_b64_tr_b16 v[208:209], v6 offset:49152
    ds_read_b64_tr_b16 v[210:211], v6 offset:50176
    ds_read_b64_tr_b16 v[212:213], v7 offset:49152
    ds_read_b64_tr_b16 v[214:215], v7 offset:50176
    s_waitcnt lgkmcnt(4)
    s_add_u32 m0, s66, 28672
    s_mov_b32 s67, 376832
    buffer_load_dwordx4 v2, s[52:55], s67 offen lds
    s_add_u32 m0, s66, 29696
    s_mov_b32 s67, 385024
    buffer_load_dwordx4 v2, s[52:55], s67 offen lds
    s_waitcnt vmcnt(28)
    v_mfma_f32_32x32x16_bf16 v[24:39], v[128:131], v[216:219], v[24:39]
    v_mfma_f32_32x32x16_bf16 v[40:55], v[128:131], v[220:223], v[40:55]
    v_mfma_f32_32x32x16_bf16 v[56:71], v[132:135], v[216:219], v[56:71]
    v_mfma_f32_32x32x16_bf16 v[72:87], v[132:135], v[220:223], v[72:87]
    buffer_load_dwordx4 v[128:131], v8, s[60:63], s69 offen offset:3072 sc1
    buffer_load_dwordx4 v[132:135], v8, s[60:63], s68 offen offset:3072 sc1
    ds_read_b64_tr_b16 v[216:217], v6 offset:51200
    ds_read_b64_tr_b16 v[218:219], v6 offset:52224
    ds_read_b64_tr_b16 v[220:221], v7 offset:51200
    ds_read_b64_tr_b16 v[222:223], v7 offset:52224
    s_waitcnt lgkmcnt(4)
    s_add_u32 m0, s66, 49152
    s_mov_b32 s67, 393216
    buffer_load_dwordx4 v2, s[52:55], s67 offen lds
    s_add_u32 m0, s66, 50176
    s_mov_b32 s67, 401408
    buffer_load_dwordx4 v2, s[52:55], s67 offen lds
    s_waitcnt vmcnt(30)
    v_mfma_f32_32x32x16_bf16 v[24:39], v[136:139], v[224:227], v[24:39]
    v_mfma_f32_32x32x16_bf16 v[40:55], v[136:139], v[228:231], v[40:55]
    v_mfma_f32_32x32x16_bf16 v[56:71], v[140:143], v[224:227], v[56:71]
    v_mfma_f32_32x32x16_bf16 v[72:87], v[140:143], v[228:231], v[72:87]
    s_bitcmp1_b32 s83, 4
    s_cbranch_scc0 L_cold_15
L_back_16:
    s_add_u32 s68, s68, 4096
    s_add_u32 s69, s69, 4096
    buffer_load_dwordx4 v[136:139], v8, s[60:63], s69 offen offset:0 sc1
    buffer_load_dwordx4 v[140:143], v8, s[60:63], s68 offen offset:0 sc1
    ds_read_b64_tr_b16 v[224:225], v6 offset:53248
    ds_read_b64_tr_b16 v[226:227], v6 offset:54272
    ds_read_b64_tr_b16 v[228:229], v7 offset:53248
    ds_read_b64_tr_b16 v[230:231], v7 offset:54272
    s_waitcnt lgkmcnt(4)
    s_add_u32 m0, s66, 51200
    s_mov_b32 s67, 409600
    buffer_load_dwordx4 v2, s[52:55], s67 offen lds
    s_add_u32 m0, s66, 52224
    s_mov_b32 s67, 417792
    buffer_load_dwordx4 v2, s[52:55], s67 offen lds
    s_waitcnt vmcnt(32)
    v_mfma_f32_32x32x16_bf16 v[24:39], v[144:147], v[232:235], v[24:39]
    v_mfma_f32_32x32x16_bf16 v[40:55], v[144:147], v[236:239], v[40:55]
    v_mfma_f32_32x32x16_bf16 v[56:71], v[148:151], v[232:235], v[56:71]
    v_mfma_f32_32x32x16_bf16 v[72:87], v[148:151], v[236:239], v[72:87]
    buffer_load_dwordx4 v[144:147], v8, s[60:63], s69 offen offset:1024 sc1
    buffer_load_dwordx4 v[148:151], v8, s[60:63], s68 offen offset:1024 sc1
    ds_read_b64_tr_b16 v[232:233], v6 offset:0
    ds_read_b64_tr_b16 v[234:235], v6 offset:1024
    ds_read_b64_tr_b16 v[236:237], v7 offset:0
    ds_read_b64_tr_b16 v[238:239], v7 offset:1024
    s_waitcnt lgkmcnt(4)
    s_add_u32 m0, s66, 53248
    s_mov_b32 s67, 425984
    buffer_load_dwordx4 v2, s[52:55], s67 offen lds
    s_add_u32 m0, s66, 54272
    s_mov_b32 s67, 434176
    buffer_load_dwordx4 v2, s[52:55], s67 offen lds
    s_waitcnt vmcnt(34)
    v_mfma_f32_32x32x16_bf16 v[24:39], v[152:155], v[240:243], v[24:39]
    v_mfma_f32_32x32x16_bf16 v[40:55], v[152:155], v[244:247], v[40:55]
    v_mfma_f32_32x32x16_bf16 v[56:71], v[156:159], v[240:243], v[56:71]
    v_mfma_f32_32x32x16_bf16 v[72:87], v[156:159], v[244:247], v[72:87]
    buffer_load_dwordx4 v[152:155], v8, s[60:63], s69 offen offset:2048 sc1
    buffer_load_dwordx4 v[156:159], v8, s[60:63], s68 offen offset:2048 sc1
    s_waitcnt vmcnt(30)
    ds_read_b64_tr_b16 v[240:241], v6 offset:2048
    ds_read_b64_tr_b16 v[242:243], v6 offset:3072
    ds_read_b64_tr_b16 v[244:245], v7 offset:2048
    ds_read_b64_tr_b16 v[246:247], v7 offset:3072
    s_waitcnt lgkmcnt(4)
    s_add_u32 m0, s66, 0
    s_mov_b32 s67, 442368
    buffer_load_dwordx4 v2, s[52:55], s67 offen lds
    s_add_u32 m0, s66, 1024
    s_mov_b32 s67, 450560
    buffer_load_dwordx4 v2, s[52:55], s67 offen lds
    v_mfma_f32_32x32x16_bf16 v[24:39], v[160:163], v[248:251], v[24:39]
    v_mfma_f32_32x32x16_bf16 v[40:55], v[160:163], v[252:255], v[40:55]
    v_mfma_f32_32x32x16_bf16 v[56:71], v[164:167], v[248:251], v[56:71]
    v_mfma_f32_32x32x16_bf16 v[72:87], v[164:167], v[252:255], v[72:87]
    buffer_load_dwordx4 v[160:163], v8, s[60:63], s69 offen offset:3072 sc1
    buffer_load_dwordx4 v[164:167], v8, s[60:63], s68 offen offset:3072 sc1
    s_waitcnt vmcnt(30)
    ds_read_b64_tr_b16 v[248:249], v6 offset:4096
    ds_read_b64_tr_b16 v[250:251], v6 offset:5120
    ds_read_b64_tr_b16 v[252:253], v7 offset:4096
    ds_read_b64_tr_b16 v[254:255], v7 offset:5120
    v_mfma_f32_32x32x16_bf16 v[24:39], v[168:171], v[88:91], v[24:39]
    v_mfma_f32_32x32x16_bf16 v[40:55], v[168:171], v[92:95], v[40:55]
    v_mfma_f32_32x32x16_bf16 v[56:71], v[172:175], v[88:91], v[56:71]
    v_mfma_f32_32x32x16_bf16 v[72:87], v[172:175], v[92:95], v[72:87]
    s_bitcmp1_b32 s83, 5
    s_cbranch_scc0 L_cold_18
L_back_19:
    s_add_u32 s68, s68, 4096
    s_add_u32 s69, s69, 4096
    buffer_load_dwordx4 v[168:171], v8, s[60:63], s69 offen offset:0 sc1
    buffer_load_dwordx4 v[172:175], v8, s[60:63], s68 offen offset:0 sc1
    s_waitcnt vmcnt(28)
    ds_read_b64_tr_b16 v[88:89], v6 offset:24576
    ds_read_b64_tr_b16 v[90:91], v6 offset:25600
    ds_read_b64_tr_b16 v[92:93], v7 offset:24576
    ds_read_b64_tr_b16 v[94:95], v7 offset:25600
    v_mfma_f32_32x32x16_bf16 v[24:39], v[176:179], v[96:99], v[24:39]
    v_mfma_f32_32x32x16_bf16 v[40:55], v[176:179], v[100:103], v[40:55]
    v_mfma_f32_32x32x16_bf16 v[56:71], v[180:183], v[96:99], v[56:71]
    v_mfma_f32_32x32x16_bf16 v[72:87], v[180:183], v[100:103], v[72:87]
    buffer_load_dwordx4 v[176:179], v8, s[60:63], s69 offen offset:1024 sc1
    buffer_load_dwordx4 v[180:183], v8, s[60:63], s68 offen offset:1024 sc1
    s_waitcnt vmcnt(26)
    ds_read_b64_tr_b16 v[96:97], v6 offset:26624
    ds_read_b64_tr_b16 v[98:99], v6 offset:27648
    ds_read_b64_tr_b16 v[100:101], v7 offset:26624
    ds_read_b64_tr_b16 v[102:103], v7 offset:27648
    v_mfma_f32_32x32x16_bf16 v[24:39], v[184:187], v[104:107], v[24:39]
    v_mfma_f32_32x32x16_bf16 v[40:55], v[184:187], v[108:111], v[40:55]
    v_mfma_f32_32x32x16_bf16 v[56:71], v[188:191], v[104:107], v[56:71]
    v_mfma_f32_32x32x16_bf16 v[72:87], v[188:191], v[108:111], v[72:87]
    buffer_load_dwordx4 v[184:187], v8, s[60:63], s69 offen offset:2048 sc1
    buffer_load_dwordx4 v[188:191], v8, s[60:63], s68 offen offset:2048 sc1
    s_waitcnt vmcnt(24)
    ds_read_b64_tr_b16 v[104:105], v6 offset:28672
    ds_read_b64_tr_b16 v[106:107], v6 offset:29696
    ds_read_b64_tr_b16 v[108:109], v7 offset:28672
    ds_read_b64_tr_b16 v[110:111], v7 offset:29696
    v_mfma_f32_32x32x16_bf16 v[24:39], v[192:195], v[112:115], v[24:39]
    v_mfma_f32_32x32x16_bf16 v[40:55], v[192:195], v[116:119], v[40:55]
    v_mfma_f32_32x32x16_bf16 v[56:71], v[196:199], v[112:115], v[56:71]
    v_mfma_f32_32x32x16_bf16 v[72:87], v[196:199], v[116:119], v[72:87]
    buffer_load_dwordx4 v[192:195], v8, s[60:63], s69 offen offset:3072 sc1
    buffer_load_dwordx4 v[196:199], v8, s[60:63], s68 offen offset:3072 sc1
    s_waitcnt vmcnt(22)
    ds_read_b64_tr_b16 v[112:113], v6 offset:49152
    ds_read_b64_tr_b16 v[114:115], v6 offset:50176
    ds_read_b64_tr_b16 v[116:117], v7 offset:49152
    ds_read_b64_tr_b16 v[118:119], v7 offset:50176
    v_mfma_f32_32x32x16_bf16 v[24:39], v[200:203], v[120:123], v[24:39]
    v_mfma_f32_32x32x16_bf16 v[40:55], v[200:203], v[124:127], v[40:55]
    v_mfma_f32_32x32x16_bf16 v[56:71], v[204:207], v[120:123], v[56:71]
    v_mfma_f32_32x32x16_bf16 v[72:87], v[204:207], v[124:127], v[72:87]
    s_bitcmp1_b32 s83, 6
    s_cbranch_scc0 L_cold_21
L_back_22:
    s_add_u32 s68, s68, 4096
    s_add_u32 s69, s69, 4096
    buffer_load_dwordx4 v[200:203], v8, s[60:63], s69 offen offset:0 sc1
    buffer_load_dwordx4 v[204:207], v8, s[60:63], s68 offen offset:0 sc1
    s_waitcnt vmcnt(20)
    ds_read_b64_tr_b16 v[120:121], v6 offset:51200
    ds_read_b64_tr_b16 v[122:123], v6 offset:52224
    ds_read_b64_tr_b16 v[124:125], v7 offset:51200
    ds_read_b64_tr_b16 v[126:127], v7 offset:52224
    v_mfma_f32_32x32x16_bf16 v[24:39], v[208:211], v[128:131], v[24:39]
    v_mfma_f32_32x32x16_bf16 v[40:55], v[208:211], v[132:135], v[40:55]
    v_mfma_f32_32x32x16_bf16 v[56:71], v[212:215], v[128:131], v[56:71]
    v_mfma_f32_32x32x16_bf16 v[72:87], v[212:215], v[132:135], v[72:87]
    buffer_load_dwordx4 v[208:211], v8, s[60:63], s69 offen offset:1024 sc1
    buffer_load_dwordx4 v[212:215], v8, s[60:63], s68 offen offset:1024 sc1
    s_waitcnt vmcnt(18)
    ds_read_b64_tr_b16 v[128:129], v6 offset:53248
    ds_read_b64_tr_b16 v[130:131], v6 offset:54272
    ds_read_b64_tr_b16 v[132:133], v7 offset:53248
    ds_read_b64_tr_b16 v[134:135], v7 offset:54272
    v_mfma_f32_32x32x16_bf16 v[24:39], v[216:219], v[136:139], v[24:39]
    v_mfma_f32_32x32x16_bf16 v[40:55], v[216:219], v[140:143], v[40:55]
    v_mfma_f32_32x32x16_bf16 v[56:71], v[220:223], v[136:139], v[56:71]
    v_mfma_f32_32x32x16_bf16 v[72:87], v[220:223], v[140:143], v[72:87]
    buffer_load_dwordx4 v[216:219], v8, s[60:63], s69 offen offset:2048 sc1
    buffer_load_dwordx4 v[220:223], v8, s[60:63], s68 offen offset:2048 sc1
    s_waitcnt vmcnt(16)
    ds_read_b64_tr_b16 v[136:137], v6 offset:0
    ds_read_b64_tr_b16 v[138:139], v6 offset:1024
    ds_read_b64_tr_b16 v[140:141], v7 offset:0
    ds_read_b64_tr_b16 v[142:143], v7 offset:1024
    v_mfma_f32_32x32x16_bf16 v[24:39], v[224:227], v[144:147], v[24:39]
    v_mfma_f32_32x32x16_bf16 v[40:55], v[224:227], v[148:151], v[40:55]
    v_mfma_f32_32x32x16_bf16 v[56:71], v[228:231], v[144:147], v[56:71]
    v_mfma_f32_32x32x16_bf16 v[72:87], v[228:231], v[148:151], v[72:87]
    buffer_load_dwordx4 v[224:227], v8, s[60:63], s69 offen offset:3072 sc1
    buffer_load_dwordx4 v[228:231], v8, s[60:63], s68 offen offset:3072 sc1
    v_mfma_f32_32x32x16_bf16 v[24:39], v[232:235], v[152:155], v[24:39]
    v_mfma_f32_32x32x16_bf16 v[40:55], v[232:235], v[156:159], v[40:55]
    v_mfma_f32_32x32x16_bf16 v[56:71], v[236:239], v[152:155], v[56:71]
    v_mfma_f32_32x32x16_bf16 v[72:87], v[236:239], v[156:159], v[72:87]
    s_waitcnt vmcnt(16) lgkmcnt(15)
    v_mfma_f32_32x32x16_bf16 v[24:39], v[240:243], v[160:163], v[24:39]
    v_mfma_f32_32x32x16_bf16 v[40:55], v[240:243], v[164:167], v[40:55]
    v_mfma_f32_32x32x16_bf16 v[56:71], v[244:247], v[160:163], v[56:71]
    v_mfma_f32_32x32x16_bf16 v[72:87], v[244:247], v[164:167], v[72:87]
    s_waitcnt vmcnt(14)
    v_mfma_f32_32x32x16_bf16 v[24:39], v[248:251], v[168:171], v[24:39]
    v_mfma_f32_32x32x16_bf16 v[40:55], v[248:251], v[172:175], v[40:55]
    v_mfma_f32_32x32x16_bf16 v[56:71], v[252:255], v[168:171], v[56:71]
    v_mfma_f32_32x32x16_bf16 v[72:87], v[252:255], v[172:175], v[72:87]
    buffer_load_dword v13, v12, s[60:63], s76 offen sc1
    s_waitcnt vmcnt(13)
    v_mfma_f32_32x32x16_bf16 v[24:39], v[88:91], v[176:179], v[24:39]
    v_mfma_f32_32x32x16_bf16 v[40:55], v[88:91], v[180:183], v[40:55]
    v_mfma_f32_32x32x16_bf16 v[56:71], v[92:95], v[176:179], v[56:71]
    v_mfma_f32_32x32x16_bf16 v[72:87], v[92:95], v[180:183], v[72:87]
    s_waitcnt lgkmcnt(0)
    s_waitcnt vmcnt(11)
    v_mfma_f32_32x32x16_bf16 v[72:87], v[100:103], v[188:191], v[72:87]
    s_waitcnt vmcnt(9)
    v_mfma_f32_32x32x16_bf16 v[72:87], v[108:111], v[196:199], v[72:87]
    s_waitcnt vmcnt(7)
    v_mfma_f32_32x32x16_bf16 v[72:87], v[116:119], v[204:207], v[72:87]
    s_waitcnt vmcnt(5)
    v_mfma_f32_32x32x16_bf16 v[72:87], v[124:127], v[212:215], v[72:87]
    s_waitcnt vmcnt(3)
    v_mfma_f32_32x32x16_bf16 v[72:87], v[132:135], v[220:223], v[72:87]
    s_waitcnt vmcnt(1)
    v_mfma_f32_32x32x16_bf16 v[72:87], v[140:143], v[228:231], v[72:87]
    v_mfma_f32_32x32x16_bf16 v[56:71], v[100:103], v[184:187], v[56:71]
    v_mfma_f32_32x32x16_bf16 v[56:71], v[108:111], v[192:195], v[56:71]
    s_nop 9
    ds_write_b128 v4, v[72:75] offset:49152
    v_mfma_f32_32x32x16_bf16 v[56:71], v[116:119], v[200:203], v[56:71]
    ds_write_b128 v4, v[76:79] offset:50176
    v_mfma_f32_32x32x16_bf16 v[56:71], v[124:127], v[208:211], v[56:71]
    ds_write_b128 v4, v[80:83] offset:51200
    v_mfma_f32_32x32x16_bf16 v[56:71], v[132:135], v[216:219], v[56:71]
    ds_write_b128 v4, v[84:87] offset:52224
    v_mfma_f32_32x32x16_bf16 v[56:71], v[140:143], v[224:227], v[56:71]
    s_waitcnt vmcnt(0)
    v_cmp_ne_u32 vcc, s46, v13
    s_cbranch_vccnz L_cold_24
L_back_25:
    s_mov_b32 s73, 12582912
    buffer_load_dword v14, v15, s[60:63], s73 offen sc1
    v_mov_b32 v144, 0
    v_mov_b32 v145, 0
    v_mov_b32 v146, 0
    v_mov_b32 v147, 0
    v_mov_b32 v148, 0
    v_mov_b32 v149, 0
    v_mov_b32 v150, 0
    v_mov_b32 v151, 0
    v_mov_b32 v232, 0
    v_mov_b32 v233, 0
    v_mov_b32 v234, 0
    v_mov_b32 v235, 0
    v_mov_b32 v236, 0
    v_mov_b32 v237, 0
    v_mov_b32 v238, 0
    v_mov_b32 v239, 0
    s_add_u32 s73, s75, 0
    buffer_load_short_d16_hi v144, v16, s[60:63], s73 offen sc1
    s_add_u32 s73, s75, 4096
    buffer_load_short_d16_hi v145, v16, s[60:63], s73 offen sc1
    s_add_u32 s73, s75, 8192
    buffer_load_short_d16_hi v146, v16, s[60:63], s73 offen sc1
    s_add_u32 s73, s75, 12288
    buffer_load_short_d16_hi v147, v16, s[60:63], s73 offen sc1
    s_add_u32 s73, s75, 32768
    buffer_load_short_d16_hi v148, v16, s[60:63], s73 offen sc1
    s_add_u32 s73, s75, 36864
    buffer_load_short_d16_hi v149, v16, s[60:63], s73 offen sc1
    s_add_u32 s73, s75, 40960
    buffer_load_short_d16_hi v150, v16, s[60:63], s73 offen sc1
    s_add_u32 s73, s75, 45056
    buffer_load_short_d16_hi v151, v16, s[60:63], s73 offen sc1
    s_add_u32 s73, s75, 65536
    buffer_load_short_d16_hi v232, v16, s[60:63], s73 offen sc1
    s_add_u32 s73, s75, 69632
    buffer_load_short_d16_hi v233, v16, s[60:63], s73 offen sc1
    s_add_u32 s73, s75, 73728
    buffer_load_short_d16_hi v234, v16, s[60:63], s73 offen sc1
    s_add_u32 s73, s75, 77824
    buffer_load_short_d16_hi v235, v16, s[60:63], s73 offen sc1
    s_add_u32 s73, s75, 98304
    buffer_load_short_d16_hi v236, v16, s[60:63], s73 offen sc1
    s_add_u32 s73, s75, 102400
    buffer_load_short_d16_hi v237, v16, s[60:63], s73 offen sc1
    s_add_u32 s73, s75, 106496
    buffer_load_short_d16_hi v238, v16, s[60:63], s73 offen sc1
    s_add_u32 s73, s75, 110592
    buffer_load_short_d16_hi v239, v16, s[60:63], s73 offen sc1
    v_mfma_f32_32x32x16_bf16 v[40:55], v[96:99], v[188:191], v[40:55]
    v_mfma_f32_32x32x16_bf16 v[40:55], v[104:107], v[196:199], v[40:55]
    s_nop 9
    ds_write_b128 v4, v[56:59] offset:24576
    v_mfma_f32_32x32x16_bf16 v[40:55], v[112:115], v[204:207], v[40:55]
    ds_write_b128 v4, v[60:63] offset:25600
    v_mfma_f32_32x32x16_bf16 v[40:55], v[120:123], v[212:215], v[40:55]
    ds_write_b128 v4, v[64:67] offset:26624
    v_mfma_f32_32x32x16_bf16 v[40:55], v[128:131], v[220:223], v[40:55]
    ds_write_b128 v4, v[68:71] offset:27648
    v_mfma_f32_32x32x16_bf16 v[40:55], v[136:139], v[228:231], v[40:55]
    v_mfma_f32_32x32x16_bf16 v[24:39], v[96:99], v[184:187], v[24:39]
    v_mfma_f32_32x32x16_bf16 v[24:39], v[104:107], v[192:195], v[24:39]
    s_nop 9
    ds_write_b128 v4, v[40:43] offset:0
    v_mfma_f32_32x32x16_bf16 v[24:39], v[112:115], v[200:203], v[24:39]
    ds_write_b128 v4, v[44:47] offset:1024
    v_mfma_f32_32x32x16_bf16 v[24:39], v[120:123], v[208:211], v[24:39]
    ds_write_b128 v4, v[48:51] offset:2048
    v_mfma_f32_32x32x16_bf16 v[24:39], v[128:131], v[216:219], v[24:39]
    ds_write_b128 v4, v[52:55] offset:3072
    v_mfma_f32_32x32x16_bf16 v[24:39], v[136:139], v[224:227], v[24:39]
    s_waitcnt vmcnt(0)
    v_sub_f32 v15, 1.0, v14
    v_cvt_pk_bf16_f32 v15, v15, v15
    v_and_b32 v15, 0xffff0000, v15
    v_mul_f32 v144, v14, v144
    v_mul_f32 v145, v14, v145
    v_mul_f32 v146, v14, v146
    v_mul_f32 v147, v14, v147
    v_mul_f32 v148, v14, v148
    v_mul_f32 v149, v14, v149
    v_mul_f32 v150, v14, v150
    v_mul_f32 v151, v14, v151
    v_mul_f32 v232, v14, v232
    v_mul_f32 v233, v14, v233
    v_mul_f32 v234, v14, v234
    v_mul_f32 v235, v14, v235
    v_mul_f32 v236, v14, v236
    v_mul_f32 v237, v14, v237
    v_mul_f32 v238, v14, v238
    v_mul_f32 v239, v14, v239
    v_cvt_pk_bf16_f32 v144, v144, v145
    v_cvt_pk_bf16_f32 v146, v146, v147
    v_cvt_pk_bf16_f32 v148, v148, v149
    v_cvt_pk_bf16_f32 v150, v150, v151
    v_cvt_pk_bf16_f32 v232, v232, v233
    v_cvt_pk_bf16_f32 v234, v234, v235
    v_cvt_pk_bf16_f32 v236, v236, v237
    v_cvt_pk_bf16_f32 v238, v238, v239
    v_and_b32 v145, 0xffff0000, v144
    v_lshlrev_b32 v144, 16, v144
    v_and_b32 v147, 0xffff0000, v146
    v_lshlrev_b32 v146, 16, v146
    v_and_b32 v149, 0xffff0000, v148
    v_lshlrev_b32 v148, 16, v148
    v_and_b32 v151, 0xffff0000, v150
    v_lshlrev_b32 v150, 16, v150
    v_and_b32 v233, 0xffff0000, v232
    v_lshlrev_b32 v232, 16, v232
    v_and_b32 v235, 0xffff0000, v234
    v_lshlrev_b32 v234, 16, v234
    v_and_b32 v237, 0xffff0000, v236
    v_lshlrev_b32 v236, 16, v236
    v_and_b32 v239, 0xffff0000, v238
    v_lshlrev_b32 v238, 16, v238
    v_bfe_u32 v13, v20, 1, 2
    v_lshlrev_b32 v9, 6, v20
    v_lshl_add_u32 v9, v13, 4, v9
    v_lshl_add_u32 v9, v11, 3, v9
    v_add_u32 v9, s66, v9
    v_xor_b32 v10, 16, v9
    v_xor_b32 v11, 32, v9
    v_xor_b32 v12, 48, v9
    v_lshrrev_b32 v5, 2, v1
    v_bfe_u32 v13, v1, 3, 2
    v_and_b32 v16, 3, v1
    v_xor_b32 v13, v13, v16
    s_lshl_b32 s72, s43, 6
    s_lshl_b32 s73, s85, 5
    s_add_u32 s72, s72, s73
    v_add_u32 v5, s72, v5
    v_lshlrev_b32 v5, 10, v5
    v_lshl_add_u32 v5, v13, 4, v5
    s_add_u32 s78, s77, 16384
    s_waitcnt lgkmcnt(0)
    s_barrier
    ds_read_b128 v[88:91], v17 offset:0
    ds_read_b128 v[92:95], v17 offset:1024
    ds_read_b128 v[96:99], v17 offset:2048
    ds_read_b128 v[100:103], v17 offset:3072
    ds_read_b128 v[104:107], v18 offset:0
    ds_read_b128 v[108:111], v18 offset:1024
    ds_read_b128 v[112:115], v18 offset:2048
    ds_read_b128 v[116:119], v18 offset:3072
    ds_read_b128 v[120:123], v19 offset:0
    ds_read_b128 v[124:127], v19 offset:1024
    ds_read_b128 v[128:131], v19 offset:2048
    ds_read_b128 v[132:135], v19 offset:3072
    s_waitcnt lgkmcnt(8)
    v_pk_add_f32 v[24:25], v[24:25], v[88:89]
    v_pk_add_f32 v[26:27], v[26:27], v[90:91]
    v_pk_add_f32 v[28:29], v[28:29], v[92:93]
    v_pk_add_f32 v[30:31], v[30:31], v[94:95]
    v_pk_add_f32 v[32:33], v[32:33], v[96:97]
    v_pk_add_f32 v[34:35], v[34:35], v[98:99]
    v_pk_add_f32 v[36:37], v[36:37], v[100:101]
    v_pk_add_f32 v[38:39], v[38:39], v[102:103]
    s_waitcnt lgkmcnt(4)
    v_pk_add_f32 v[24:25], v[24:25], v[104:105]
    v_pk_add_f32 v[26:27], v[26:27], v[106:107]
    v_pk_add_f32 v[28:29], v[28:29], v[108:109]
    v_pk_add_f32 v[30:31], v[30:31], v[110:111]
    v_pk_add_f32 v[32:33], v[32:33], v[112:113]
    v_pk_add_f32 v[34:35], v[34:35], v[114:115]
    v_pk_add_f32 v[36:37], v[36:37], v[116:117]
    v_pk_add_f32 v[38:39], v[38:39], v[118:119]
    s_waitcnt lgkmcnt(0)
    v_pk_add_f32 v[24:25], v[24:25], v[120:121]
    v_pk_add_f32 v[26:27], v[26:27], v[122:123]
    v_pk_add_f32 v[28:29], v[28:29], v[124:125]
    v_pk_add_f32 v[30:31], v[30:31], v[126:127]
    v_pk_add_f32 v[32:33], v[32:33], v[128:129]
    v_pk_add_f32 v[34:35], v[34:35], v[130:131]
    v_pk_add_f32 v[36:37], v[36:37], v[132:133]
    v_pk_add_f32 v[38:39], v[38:39], v[134:135]
    v_cvt_pk_bf16_f32 v24, v24, v25
    v_cvt_pk_bf16_f32 v26, v26, v27
    v_cvt_pk_bf16_f32 v28, v28, v29
    v_cvt_pk_bf16_f32 v30, v30, v31
    v_cvt_pk_bf16_f32 v32, v32, v33
    v_cvt_pk_bf16_f32 v34, v34, v35
    v_cvt_pk_bf16_f32 v36, v36, v37
    v_cvt_pk_bf16_f32 v38, v38, v39
    v_and_b32 v25, 0xffff0000, v24
    v_lshlrev_b32 v24, 16, v24
    v_and_b32 v27, 0xffff0000, v26
    v_lshlrev_b32 v26, 16, v26
    v_and_b32 v29, 0xffff0000, v28
    v_lshlrev_b32 v28, 16, v28
    v_and_b32 v31, 0xffff0000, v30
    v_lshlrev_b32 v30, 16, v30
    v_and_b32 v33, 0xffff0000, v32
    v_lshlrev_b32 v32, 16, v32
    v_and_b32 v35, 0xffff0000, v34
    v_lshlrev_b32 v34, 16, v34
    v_and_b32 v37, 0xffff0000, v36
    v_lshlrev_b32 v36, 16, v36
    v_and_b32 v39, 0xffff0000, v38
    v_lshlrev_b32 v38, 16, v38
    v_pk_mul_f32 v[24:25], v[24:25], v[14:15] op_sel:[0,1] op_sel_hi:[1,1]
    v_pk_mul_f32 v[26:27], v[26:27], v[14:15] op_sel:[0,1] op_sel_hi:[1,1]
    v_pk_mul_f32 v[28:29], v[28:29], v[14:15] op_sel:[0,1] op_sel_hi:[1,1]
    v_pk_mul_f32 v[30:31], v[30:31], v[14:15] op_sel:[0,1] op_sel_hi:[1,1]
    v_pk_mul_f32 v[32:33], v[32:33], v[14:15] op_sel:[0,1] op_sel_hi:[1,1]
    v_pk_mul_f32 v[34:35], v[34:35], v[14:15] op_sel:[0,1] op_sel_hi:[1,1]
    v_pk_mul_f32 v[36:37], v[36:37], v[14:15] op_sel:[0,1] op_sel_hi:[1,1]
    v_pk_mul_f32 v[38:39], v[38:39], v[14:15] op_sel:[0,1] op_sel_hi:[1,1]
    v_cvt_pk_bf16_f32 v24, v24, v25
    v_cvt_pk_bf16_f32 v26, v26, v27
    v_cvt_pk_bf16_f32 v28, v28, v29
    v_cvt_pk_bf16_f32 v30, v30, v31
    v_cvt_pk_bf16_f32 v32, v32, v33
    v_cvt_pk_bf16_f32 v34, v34, v35
    v_cvt_pk_bf16_f32 v36, v36, v37
    v_cvt_pk_bf16_f32 v38, v38, v39
    v_and_b32 v25, 0xffff0000, v24
    v_lshlrev_b32 v24, 16, v24
    v_and_b32 v27, 0xffff0000, v26
    v_lshlrev_b32 v26, 16, v26
    v_and_b32 v29, 0xffff0000, v28
    v_lshlrev_b32 v28, 16, v28
    v_and_b32 v31, 0xffff0000, v30
    v_lshlrev_b32 v30, 16, v30
    v_and_b32 v33, 0xffff0000, v32
    v_lshlrev_b32 v32, 16, v32
    v_and_b32 v35, 0xffff0000, v34
    v_lshlrev_b32 v34, 16, v34
    v_and_b32 v37, 0xffff0000, v36
    v_lshlrev_b32 v36, 16, v36
    v_and_b32 v39, 0xffff0000, v38
    v_lshlrev_b32 v38, 16, v38
    v_pk_add_f32 v[24:25], v[24:25], v[144:145]
    v_pk_add_f32 v[26:27], v[26:27], v[146:147]
    v_pk_add_f32 v[28:29], v[28:29], v[148:149]
    v_pk_add_f32 v[30:31], v[30:31], v[150:151]
    v_pk_add_f32 v[32:33], v[32:33], v[232:233]
    v_pk_add_f32 v[34:35], v[34:35], v[234:235]
    v_pk_add_f32 v[36:37], v[36:37], v[236:237]
    v_pk_add_f32 v[38:39], v[38:39], v[238:239]
    v_cvt_pk_bf16_f32 v136, v24, v25
    v_cvt_pk_bf16_f32 v137, v26, v27
    v_cvt_pk_bf16_f32 v138, v28, v29
    v_cvt_pk_bf16_f32 v139, v30, v31
    v_cvt_pk_bf16_f32 v140, v32, v33
    v_cvt_pk_bf16_f32 v141, v34, v35
    v_cvt_pk_bf16_f32 v142, v36, v37
    v_cvt_pk_bf16_f32 v143, v38, v39
    ds_write_b64 v9, v[136:137] offset:4096
    ds_write_b64 v10, v[138:139] offset:4096
    ds_write_b64 v11, v[140:141] offset:4096
    ds_write_b64 v12, v[142:143] offset:4096
    ds_read_b128 v[88:91], v4 offset:4096
    ds_read_b128 v[92:95], v4 offset:5120
    s_waitcnt lgkmcnt(0)
    buffer_store_dwordx4 v[88:91], v5, s[56:59], s77 offen sc1
    buffer_store_dwordx4 v[92:95], v5, s[56:59], s78 offen sc1
    s_endpgm
L_H:
    s_mov_b32 s60, s36
    s_mov_b32 s61, s37
    s_mov_b32 s62, 0xe00000
    s_mov_b32 s63, 0x20000
    s_cmp_lt_u32 s40, 4
    s_cbranch_scc1 L_Haux
    s_mov_b32 s48, s4
    s_mov_b32 s49, s5
    s_mov_b32 s50, 0x200000
    s_mov_b32 s51, 0x20000
    s_mov_b32 s52, s24
    s_mov_b32 s53, s25
    s_mov_b32 s54, 0x1c0000
    s_mov_b32 s55, 0x20000
    s_mov_b32 s56, s26
    s_mov_b32 s57, s27
    s_mov_b32 s58, 0x1c0000
    s_mov_b32 s59, 0x20000
    v_lshrrev_b32 v16, 4, v1
    v_bfe_u32 v17, v1, 1, 3
    v_xor_b32 v17, v17, v16
    v_mul_u32_u24 v2, 3584, v16
    v_lshl_add_u32 v2, v17, 5, v2
    v_and_b32 v17, 1, v1
    v_lshl_add_u32 v2, v17, 4, v2
    s_lshl_b32 s70, s42, 8
    s_mul_i32 s71, s45, 28672
    s_add_u32 s70, s70, s71
    v_xor_b32 v3, 0x80, v2
    v_add_u32 v2, s70, v2
    v_add_u32 v3, s70, v3
    v_lshrrev_b32 v4, 2, v1
    v_lshlrev_b32 v4, 10, v4
    v_and_b32 v17, 3, v1
    v_xor_b32 v17, v17, v16
    v_lshl_add_u32 v4, v17, 4, v4
    s_lshl_b32 s70, s41, 17
    s_lshl_b32 s71, s45, 15
    s_add_u32 s70, s70, s71
    v_add_u32 v4, s70, v4
    s_lshl_b32 s72, s45, 11
    s_lshr_b32 s87, s39, 1
    s_mul_i32 s87, s87, 4
    s_add_u32 s88, s87, 0
    s_and_b32 s88, s88, 15
    s_mul_i32 s89, s88, 114688
    s_lshl_b32 s88, s88, 6
    s_add_u32 m0, s72, 65536
    s_add_u32 s73, s89, 0
    buffer_load_dwordx4 v2, s[52:55], s73 offen lds
    s_add_u32 m0, s72, 66560
    s_add_u32 s73, s89, 14336
    buffer_load_dwordx4 v2, s[52:55], s73 offen lds
    s_add_u32 m0, s72, 73728
    s_add_u32 s73, s89, 0
    buffer_load_dwordx4 v3, s[56:59], s73 offen lds
    s_add_u32 m0, s72, 74752
    s_add_u32 s73, s89, 14336
    buffer_load_dwordx4 v3, s[56:59], s73 offen lds
    s_add_u32 m0, s72, 81920
    s_add_u32 s73, s88, 0
    buffer_load_dwordx4 v4, s[48:51], s73 offen lds
    s_add_u32 m0, s72, 82944
    s_add_u32 s73, s88, 16384
    buffer_load_dwordx4 v4, s[48:51], s73 offen lds
    s_mul_i32 s68, s84, 17408
    s_add_u32 s68, s68, 1024
    s_lshl_b32 s70, s45, 4
    s_add_u32 s70, s70, 0
    v_mov_b32 v29, s70
    v_xor_b32 v30, 16, v29
    v_mov_b32 v176, 0
    v_mov_b32 v177, 0
    v_mov_b32 v178, 0
    v_mov_b32 v179, 0
    ds_write_b128 v29, v[176:179]
    v_mov_b32 v28, 64
    v_lshlrev_b32 v22, 4, v1
    s_lshl_b32 s78, s45, 12
    s_add_u32 s78, s78, 139264
    v_add_u32 v24, s78, v22
    v_xor_b32 v25, 0x1000, v24
    s_mul_i32 s71, s45, 6144
    s_add_u32 s71, s71, 40960
    v_add_u32 v23, s71, v22
    ds_write_b128 v28, v[176:179]
    ds_write_b128 v28, v[176:179] offset:32
    s_add_u32 s88, s87, 1
    s_and_b32 s88, s88, 15
    s_mul_i32 s89, s88, 114688
    s_lshl_b32 s88, s88, 6
    s_add_u32 m0, s72, 90112
    s_add_u32 s73, s89, 0
    buffer_load_dwordx4 v2, s[52:55], s73 offen lds
    s_add_u32 m0, s72, 91136
    s_add_u32 s73, s89, 14336
    buffer_load_dwordx4 v2, s[52:55], s73 offen lds
    s_add_u32 m0, s72, 98304
    s_add_u32 s73, s89, 0
    buffer_load_dwordx4 v3, s[56:59], s73 offen lds
    s_add_u32 m0, s72, 99328
    s_add_u32 s73, s89, 14336
    buffer_load_dwordx4 v3, s[56:59], s73 offen lds
    s_add_u32 m0, s72, 106496
    s_add_u32 s73, s88, 0
    buffer_load_dwordx4 v4, s[48:51], s73 offen lds
    s_add_u32 m0, s72, 107520
    s_add_u32 s73, s88, 16384
    buffer_load_dwordx4 v4, s[48:51], s73 offen lds
    s_add_u32 s88, s87, 2
    s_and_b32 s88, s88, 15
    s_mul_i32 s89, s88, 114688
    s_lshl_b32 s88, s88, 6
    s_add_u32 m0, s72, 114688
    s_add_u32 s73, s89, 0
    buffer_load_dwordx4 v2, s[52:55], s73 offen lds
    s_add_u32 m0, s72, 115712
    s_add_u32 s73, s89, 14336
    buffer_load_dwordx4 v2, s[52:55], s73 offen lds
    s_add_u32 m0, s72, 122880
    s_add_u32 s73, s89, 0
    buffer_load_dwordx4 v3, s[56:59], s73 offen lds
    s_add_u32 m0, s72, 123904
    s_add_u32 s73, s89, 14336
    buffer_load_dwordx4 v3, s[56:59], s73 offen lds
    s_add_u32 m0, s72, 131072
    s_add_u32 s73, s88, 0
    buffer_load_dwordx4 v4, s[48:51], s73 offen lds
    s_add_u32 m0, s72, 132096
    s_add_u32 s73, s88, 16384
    buffer_load_dwordx4 v4, s[48:51], s73 offen lds
    s_add_u32 s88, s87, 3
    s_and_b32 s88, s88, 15
    s_mul_i32 s89, s88, 114688
    s_lshl_b32 s88, s88, 6
    s_add_u32 m0, s72, 139264
    s_add_u32 s73, s89, 0
    buffer_load_dwordx4 v2, s[52:55], s73 offen lds
    s_add_u32 m0, s72, 140288
    s_add_u32 s73, s89, 14336
    buffer_load_dwordx4 v2, s[52:55], s73 offen lds
    s_add_u32 m0, s72, 147456
    s_add_u32 s73, s89, 0
    buffer_load_dwordx4 v3, s[56:59], s73 offen lds
    s_add_u32 m0, s72, 148480
    s_add_u32 s73, s89, 14336
    buffer_load_dwordx4 v3, s[56:59], s73 offen lds
    s_add_u32 m0, s72, 155648
    s_add_u32 s73, s88, 0
    buffer_load_dwordx4 v4, s[48:51], s73 offen lds
    s_add_u32 m0, s72, 156672
    s_add_u32 s73, s88, 16384
    buffer_load_dwordx4 v4, s[48:51], s73 offen lds
    s_add_u32 s88, s87, 4
    s_and_b32 s88, s88, 15
    s_mul_i32 s89, s88, 114688
    s_lshl_b32 s88, s88, 6
    s_add_u32 m0, s72, 40960
    s_add_u32 s73, s89, 0
    buffer_load_dwordx4 v2, s[52:55], s73 offen lds
    s_add_u32 m0, s72, 41984
    s_add_u32 s73, s89, 14336
    buffer_load_dwordx4 v2, s[52:55], s73 offen lds
    s_add_u32 m0, s72, 49152
    s_add_u32 s73, s89, 0
    buffer_load_dwordx4 v3, s[56:59], s73 offen lds
    s_add_u32 m0, s72, 50176
    s_add_u32 s73, s89, 14336
    buffer_load_dwordx4 v3, s[56:59], s73 offen lds
    s_add_u32 m0, s72, 57344
    s_add_u32 s73, s88, 0
    buffer_load_dwordx4 v4, s[48:51], s73 offen lds
    s_add_u32 m0, s72, 58368
    s_add_u32 s73, s88, 16384
    buffer_load_dwordx4 v4, s[48:51], s73 offen lds
    s_waitcnt vmcnt(24)
    s_waitcnt lgkmcnt(0)
    s_barrier
    v_add_u32 v16, s68, v22
    ds_read_b128 v[128:131], v16 offset:0
    ds_read_b128 v[132:135], v16 offset:1024
    ds_read_b128 v[136:139], v16 offset:2048
    ds_read_b128 v[140:143], v16 offset:3072
    ds_read_b128 v[104:107], v16 offset:8704
    ds_read_b128 v[108:111], v16 offset:9728
    ds_read_b128 v[112:115], v16 offset:10752
    ds_read_b128 v[116:119], v16 offset:11776
    s_waitcnt lgkmcnt(0)
    v_add_f32 v128, v128, v104
    v_add_f32 v129, v129, v105
    v_add_f32 v130, v130, v106
    v_add_f32 v131, v131, v107
    v_add_f32 v132, v132, v108
    v_add_f32 v133, v133, v109
    v_add_f32 v134, v134, v110
    v_add_f32 v135, v135, v111
    v_add_f32 v136, v136, v112
    v_add_f32 v137, v137, v113
    v_add_f32 v138, v138, v114
    v_add_f32 v139, v139, v115
    v_add_f32 v140, v140, v116
    v_add_f32 v141, v141, v117
    v_add_f32 v142, v142, v118
    v_add_f32 v143, v143, v119
    s_waitcnt vmcnt(18)
    s_barrier
    s_add_u32 s88, s87, 5
    s_and_b32 s88, s88, 15
    s_mul_i32 s89, s88, 114688
    s_lshl_b32 s88, s88, 6
    s_add_u32 m0, s72, 1024
    s_add_u32 s73, s89, 0
    buffer_load_dwordx4 v2, s[52:55], s73 offen lds
    s_add_u32 m0, s72, 2048
    s_add_u32 s73, s89, 14336
    buffer_load_dwordx4 v2, s[52:55], s73 offen lds
    s_add_u32 m0, s72, 9216
    s_add_u32 s73, s89, 0
    buffer_load_dwordx4 v3, s[56:59], s73 offen lds
    s_add_u32 m0, s72, 10240
    s_add_u32 s73, s89, 14336
    buffer_load_dwordx4 v3, s[56:59], s73 offen lds
    s_add_u32 m0, s72, 17408
    s_add_u32 s73, s88, 0
    buffer_load_dwordx4 v4, s[48:51], s73 offen lds
    s_add_u32 m0, s72, 18432
    s_add_u32 s73, s88, 16384
    buffer_load_dwordx4 v4, s[48:51], s73 offen lds
    s_waitcnt vmcnt(18)
    s_barrier
    s_add_u32 s88, s87, 6
    s_and_b32 s88, s88, 15
    s_mul_i32 s89, s88, 114688
    s_lshl_b32 s88, s88, 6
    s_add_u32 m0, s72, 65536
    s_add_u32 s73, s89, 0
    buffer_load_dwordx4 v2, s[52:55], s73 offen lds
    s_add_u32 m0, s72, 66560
    s_add_u32 s73, s89, 14336
    buffer_load_dwordx4 v2, s[52:55], s73 offen lds
    s_add_u32 m0, s72, 73728
    s_add_u32 s73, s89, 0
    buffer_load_dwordx4 v3, s[56:59], s73 offen lds
    s_add_u32 m0, s72, 74752
    s_add_u32 s73, s89, 14336
    buffer_load_dwordx4 v3, s[56:59], s73 offen lds
    s_add_u32 m0, s72, 81920
    s_add_u32 s73, s88, 0
    buffer_load_dwordx4 v4, s[48:51], s73 offen lds
    s_add_u32 m0, s72, 82944
    s_add_u32 s73, s88, 16384
    buffer_load_dwordx4 v4, s[48:51], s73 offen lds
    s_waitcnt vmcnt(18)
    s_barrier
    s_add_u32 s88, s87, 7
    s_and_b32 s88, s88, 15
    s_mul_i32 s89, s88, 114688
    s_lshl_b32 s88, s88, 6
    s_add_u32 m0, s72, 90112
    s_add_u32 s73, s89, 0
    buffer_load_dwordx4 v2, s[52:55], s73 offen lds
    s_add_u32 m0, s72, 91136
    s_add_u32 s73, s89, 14336
    buffer_load_dwordx4 v2, s[52:55], s73 offen lds
    s_add_u32 m0, s72, 98304
    s_add_u32 s73, s89, 0
    buffer_load_dwordx4 v3, s[56:59], s73 offen lds
    s_add_u32 m0, s72, 99328
    s_add_u32 s73, s89, 14336
    buffer_load_dwordx4 v3, s[56:59], s73 offen lds
    s_add_u32 m0, s72, 106496
    s_add_u32 s73, s88, 0
    buffer_load_dwordx4 v4, s[48:51], s73 offen lds
    s_add_u32 m0, s72, 107520
    s_add_u32 s73, s88, 16384
    buffer_load_dwordx4 v4, s[48:51], s73 offen lds
    s_waitcnt vmcnt(18)
    s_barrier
    s_add_u32 s88, s87, 8
    s_and_b32 s88, s88, 15
    s_mul_i32 s89, s88, 114688
    s_lshl_b32 s88, s88, 6
    s_add_u32 m0, s72, 114688
    s_add_u32 s73, s89, 0
    buffer_load_dwordx4 v2, s[52:55], s73 offen lds
    s_add_u32 m0, s72, 115712
    s_add_u32 s73, s89, 14336
    buffer_load_dwordx4 v2, s[52:55], s73 offen lds
    s_add_u32 m0, s72, 122880
    s_add_u32 s73, s89, 0
    buffer_load_dwordx4 v3, s[56:59], s73 offen lds
    s_add_u32 m0, s72, 123904
    s_add_u32 s73, s89, 14336
    buffer_load_dwordx4 v3, s[56:59], s73 offen lds
    s_add_u32 m0, s72, 131072
    s_add_u32 s73, s88, 0
    buffer_load_dwordx4 v4, s[48:51], s73 offen lds
    s_add_u32 m0, s72, 132096
    s_add_u32 s73, s88, 16384
    buffer_load_dwordx4 v4, s[48:51], s73 offen lds
    s_waitcnt vmcnt(18)
    s_barrier
    s_add_u32 s88, s87, 9
    s_and_b32 s88, s88, 15
    s_mul_i32 s89, s88, 114688
    s_lshl_b32 s88, s88, 6
    s_add_u32 m0, s72, 139264
    s_add_u32 s73, s89, 0
    buffer_load_dwordx4 v2, s[52:55], s73 offen lds
    s_add_u32 m0, s72, 140288
    s_add_u32 s73, s89, 14336
    buffer_load_dwordx4 v2, s[52:55], s73 offen lds
    s_add_u32 m0, s72, 147456
    s_add_u32 s73, s89, 0
    buffer_load_dwordx4 v3, s[56:59], s73 offen lds
    s_add_u32 m0, s72, 148480
    s_add_u32 s73, s89, 14336
    buffer_load_dwordx4 v3, s[56:59], s73 offen lds
    s_add_u32 m0, s72, 155648
    s_add_u32 s73, s88, 0
    buffer_load_dwordx4 v4, s[48:51], s73 offen lds
    s_add_u32 m0, s72, 156672
    s_add_u32 s73, s88, 16384
    buffer_load_dwordx4 v4, s[48:51], s73 offen lds
    s_waitcnt vmcnt(18)
    s_barrier
    s_add_u32 s88, s87, 10
    s_and_b32 s88, s88, 15
    s_mul_i32 s89, s88, 114688
    s_lshl_b32 s88, s88, 6
    s_add_u32 m0, s72, 40960
    s_add_u32 s73, s89, 0
    buffer_load_dwordx4 v2, s[52:55], s73 offen lds
    s_add_u32 m0, s72, 41984
    s_add_u32 s73, s89, 14336
    buffer_load_dwordx4 v2, s[52:55], s73 offen lds
    s_add_u32 m0, s72, 49152
    s_add_u32 s73, s89, 0
    buffer_load_dwordx4 v3, s[56:59], s73 offen lds
    s_add_u32 m0, s72, 50176
    s_add_u32 s73, s89, 14336
    buffer_load_dwordx4 v3, s[56:59], s73 offen lds
    s_add_u32 m0, s72, 57344
    s_add_u32 s73, s88, 0
    buffer_load_dwordx4 v4, s[48:51], s73 offen lds
    s_add_u32 m0, s72, 58368
    s_add_u32 s73, s88, 16384
    buffer_load_dwordx4 v4, s[48:51], s73 offen lds
    s_waitcnt vmcnt(18)
    s_barrier
    s_add_u32 s88, s87, 11
    s_and_b32 s88, s88, 15
    s_mul_i32 s89, s88, 114688
    s_lshl_b32 s88, s88, 6
    s_add_u32 m0, s72, 1024
    s_add_u32 s73, s89, 0
    buffer_load_dwordx4 v2, s[52:55], s73 offen lds
    s_add_u32 m0, s72, 2048
    s_add_u32 s73, s89, 14336
    buffer_load_dwordx4 v2, s[52:55], s73 offen lds
    s_add_u32 m0, s72, 9216
    s_add_u32 s73, s89, 0
    buffer_load_dwordx4 v3, s[56:59], s73 offen lds
    s_add_u32 m0, s72, 10240
    s_add_u32 s73, s89, 14336
    buffer_load_dwordx4 v3, s[56:59], s73 offen lds
    s_add_u32 m0, s72, 17408
    s_add_u32 s73, s88, 0
    buffer_load_dwordx4 v4, s[48:51], s73 offen lds
    s_add_u32 m0, s72, 18432
    s_add_u32 s73, s88, 16384
    buffer_load_dwordx4 v4, s[48:51], s73 offen lds
    s_waitcnt vmcnt(18)
    s_barrier
    s_add_u32 s88, s87, 12
    s_and_b32 s88, s88, 15
    s_mul_i32 s89, s88, 114688
    s_lshl_b32 s88, s88, 6
    s_add_u32 m0, s72, 65536
    s_add_u32 s73, s89, 0
    buffer_load_dwordx4 v2, s[52:55], s73 offen lds
    s_add_u32 m0, s72, 66560
    s_add_u32 s73, s89, 14336
    buffer_load_dwordx4 v2, s[52:55], s73 offen lds
    s_add_u32 m0, s72, 73728
    s_add_u32 s73, s89, 0
    buffer_load_dwordx4 v3, s[56:59], s73 offen lds
    s_add_u32 m0, s72, 74752
    s_add_u32 s73, s89, 14336
    buffer_load_dwordx4 v3, s[56:59], s73 offen lds
    s_add_u32 m0, s72, 81920
    s_add_u32 s73, s88, 0
    buffer_load_dwordx4 v4, s[48:51], s73 offen lds
    s_add_u32 m0, s72, 82944
    s_add_u32 s73, s88, 16384
    buffer_load_dwordx4 v4, s[48:51], s73 offen lds
    s_waitcnt vmcnt(18)
    s_barrier
    s_add_u32 s88, s87, 13
    s_and_b32 s88, s88, 15
    s_mul_i32 s89, s88, 114688
    s_lshl_b32 s88, s88, 6
    s_add_u32 m0, s72, 90112
    s_add_u32 s73, s89, 0
    buffer_load_dwordx4 v2, s[52:55], s73 offen lds
    s_add_u32 m0, s72, 91136
    s_add_u32 s73, s89, 14336
    buffer_load_dwordx4 v2, s[52:55], s73 offen lds
    s_add_u32 m0, s72, 98304
    s_add_u32 s73, s89, 0
    buffer_load_dwordx4 v3, s[56:59], s73 offen lds
    s_add_u32 m0, s72, 99328
    s_add_u32 s73, s89, 14336
    buffer_load_dwordx4 v3, s[56:59], s73 offen lds
    s_add_u32 m0, s72, 106496
    s_add_u32 s73, s88, 0
    buffer_load_dwordx4 v4, s[48:51], s73 offen lds
    s_add_u32 m0, s72, 107520
    s_add_u32 s73, s88, 16384
    buffer_load_dwordx4 v4, s[48:51], s73 offen lds
    s_waitcnt vmcnt(18)
    s_barrier
    s_add_u32 s88, s87, 14
    s_and_b32 s88, s88, 15
    s_mul_i32 s89, s88, 114688
    s_lshl_b32 s88, s88, 6
    s_add_u32 m0, s72, 114688
    s_add_u32 s73, s89, 0
    buffer_load_dwordx4 v2, s[52:55], s73 offen lds
    s_add_u32 m0, s72, 115712
    s_add_u32 s73, s89, 14336
    buffer_load_dwordx4 v2, s[52:55], s73 offen lds
    s_add_u32 m0, s72, 122880
    s_add_u32 s73, s89, 0
    buffer_load_dwordx4 v3, s[56:59], s73 offen lds
    s_add_u32 m0, s72, 123904
    s_add_u32 s73, s89, 14336
    buffer_load_dwordx4 v3, s[56:59], s73 offen lds
    s_add_u32 m0, s72, 131072
    s_add_u32 s73, s88, 0
    buffer_load_dwordx4 v4, s[48:51], s73 offen lds
    s_add_u32 m0, s72, 132096
    s_add_u32 s73, s88, 16384
    buffer_load_dwordx4 v4, s[48:51], s73 offen lds
    s_waitcnt vmcnt(18)
    s_barrier
    s_add_u32 s88, s87, 15
    s_and_b32 s88, s88, 15
    s_mul_i32 s89, s88, 114688
    s_lshl_b32 s88, s88, 6
    s_add_u32 m0, s72, 139264
    s_add_u32 s73, s89, 0
    buffer_load_dwordx4 v2, s[52:55], s73 offen lds
    s_add_u32 m0, s72, 140288
    s_add_u32 s73, s89, 14336
    buffer_load_dwordx4 v2, s[52:55], s73 offen lds
    s_add_u32 m0, s72, 147456
    s_add_u32 s73, s89, 0
    buffer_load_dwordx4 v3, s[56:59], s73 offen lds
    s_add_u32 m0, s72, 148480
    s_add_u32 s73, s89, 14336
    buffer_load_dwordx4 v3, s[56:59], s73 offen lds
    s_add_u32 m0, s72, 155648
    s_add_u32 s73, s88, 0
    buffer_load_dwordx4 v4, s[48:51], s73 offen lds
    s_add_u32 m0, s72, 156672
    s_add_u32 s73, s88, 16384
    buffer_load_dwordx4 v4, s[48:51], s73 offen lds
    v_mov_b32 v245, 0
    global_load_dword v244, v245, s[34:35] sc1
    s_waitcnt vmcnt(19)
    s_barrier
    v_and_b32 v16, 15, v1
    v_lshrrev_b32 v17, 4, v1
    v_and_b32 v18, 1, v16
    v_cmp_eq_u32 vcc, 0, v18
    s_nop 1
    v_cndmask_b32 v144, v141, v140, vcc
    v_cndmask_b32 v145, v143, v142, vcc
    s_cmp_eq_u32 s85, 0
    s_cselect_b64 vcc, -1, 0
    v_cndmask_b32 v184, v140, v128, vcc
    v_cndmask_b32 v185, v140, v129, vcc
    v_cndmask_b32 v186, v140, v130, vcc
    v_cndmask_b32 v187, v140, v131, vcc
    v_cndmask_b32 v188, v144, v132, vcc
    v_cndmask_b32 v189, v141, v133, vcc
    v_cndmask_b32 v190, v141, v134, vcc
    v_cndmask_b32 v191, v141, v135, vcc
    v_cndmask_b32 v192, v141, v136, vcc
    v_cndmask_b32 v193, v142, v137, vcc
    v_cndmask_b32 v194, v142, v137, vcc
    v_cndmask_b32 v195, v142, v137, vcc
    v_cndmask_b32 v196, v142, v138, vcc
    v_cndmask_b32 v197, v145, v138, vcc
    v_cndmask_b32 v198, v143, v138, vcc
    v_cndmask_b32 v199, v143, v139, vcc
    v_cndmask_b32 v200, v143, v139, vcc
    v_cndmask_b32 v201, v143, v139, vcc
    v_lshlrev_b32 v19, 4, v16
    v_sub_u32 v19, 4064, v19
    v_add_u32 v19, s68, v19
    s_add_u32 s70, s85, 8
    v_lshlrev_b32 v20, s70, v17
    v_sub_u32 v20, v19, v20
    s_lshl_b32 s70, s85, 11
    v_subrev_u32 v20, s70, v20
    s_cmp_eq_u32 s85, 0
    s_cselect_b32 s70, 4, 1
    s_lshl_b32 s70, s70, 8
    v_subrev_u32 v21, s70, v20
    v_mul_u32_u24 v26, 4160, v17
    v_lshl_add_u32 v26, v16, 2, v26
    v_add_u32 v26, s68, v26
    v_cvt_pk_bf16_f32 v204, v191, v190
    v_cvt_pk_bf16_f32 v205, v189, v188
    v_cvt_pk_bf16_f32 v206, v187, v186
    v_cvt_pk_bf16_f32 v207, v185, v184
    v_cvt_pk_bf16_f32 v208, v192, v191
    v_cvt_pk_bf16_f32 v209, v190, v189
    v_cvt_pk_bf16_f32 v210, v188, v187
    v_cvt_pk_bf16_f32 v211, v186, v185
    v_mov_b32 v212, v205
    v_mov_b32 v213, v206
    v_mov_b32 v214, v209
    v_mov_b32 v215, v210
    v_cvt_pk_bf16_f32 v216, v200, v199
    v_cvt_pk_bf16_f32 v217, v198, v197
    v_cvt_pk_bf16_f32 v218, v196, v195
    v_cvt_pk_bf16_f32 v219, v194, v193
    v_cvt_pk_bf16_f32 v220, v201, v200
    v_cvt_pk_bf16_f32 v221, v199, v198
    v_cvt_pk_bf16_f32 v222, v197, v196
    v_cvt_pk_bf16_f32 v223, v195, v194
    v_mov_b32 v224, v217
    v_mov_b32 v225, v218
    v_mov_b32 v226, v221
    v_mov_b32 v227, v222
    v_cvt_pk_bf16_f32 v27, v128, v128
    s_mov_b32 s52, s28
    s_mov_b32 s53, s29
    s_mov_b32 s54, 0x1c0000
    s_mov_b32 s55, 0x20000
    v_lshrrev_b32 v16, 3, v1
    v_lshlrev_b32 v2, 10, v16
    v_and_b32 v16, 2, v16
    v_bfe_u32 v17, v1, 1, 2
    v_xor_b32 v16, v16, v17
    v_lshl_add_u32 v2, v16, 5, v2
    v_and_b32 v16, 1, v1
    v_lshl_add_u32 v2, v16, 4, v2
    s_lshl_b32 s64, s44, 7
    s_mul_i32 s65, s45, 458752
    s_add_u32 s64, s64, s65
    v_add_u32 v2, s64, v2
    s_mul_i32 s66, s45, 6144
    s_add_u32 s66, s66, 65536
    s_waitcnt vmcnt(13)
    s_barrier
    s_waitcnt vmcnt(0)
    v_readfirstlane_b32 s46, v244
    s_cmp_lg_u32 s46, 0
    s_cbranch_scc0 L_cold_27
L_back_28:
    v_mov_b32 v245, 80
    v_mov_b32 v244, s46
    ds_write_b32 v245, v244
    v_and_b32 v246, 31, v1
    v_lshlrev_b32 v246, 7, v246
    s_lshr_b32 s79, s86, 7
    s_lshl_b32 s79, s79, 12
    s_add_u32 s79, s79, 12910592
    s_lshl_b32 s90, s86, 12
    s_add_u32 s90, s90, 8388608
    buffer_load_dword v247, v246, s[60:63], s79 offen sc1
    v_and_b32 v16, 31, v1
    v_lshrrev_b32 v17, 5, v1
    v_mul_u32_u24 v249, 1536, v17
    v_lshl_add_u32 v249, v16, 4, v249
    v_add_u32 v249, s71, v249
    v_sub_u32 v18, 3, v16
    v_and_b32 v18, 3, v18
    v_mul_u32_u24 v18, 4158, v18
    v_sub_u32 v19, 31, v16
    v_lshl_add_u32 v19, v17, 3, v19
    v_lshl_add_u32 v18, v19, 1, v18
    s_lshl_b32 s70, s85, 10
    s_sub_u32 s70, s68, s70
    v_add_u32 v18, s70, v18
    s_lshl_b32 s70, s85, 8
    s_sub_u32 s70, 256, s70
    v_add_u32 v19, s70, v249
    v_and_b32 v248, 3, v1
    v_mul_u32_u24 v248, 1536, v248
    v_lshrrev_b32 v5, 2, v1
    v_lshl_add_u32 v248, v5, 4, v248
    v_add_u32 v248, s71, v248
    s_barrier
    s_add_u32 m0, s66, 0
    s_mov_b32 s67, 0
    buffer_load_dwordx4 v2, s[52:55], s67 offen lds
    s_add_u32 m0, s66, 1024
    s_mov_b32 s67, 8192
    buffer_load_dwordx4 v2, s[52:55], s67 offen lds
    s_add_u32 m0, s66, 2048
    s_mov_b32 s67, 16384
    buffer_load_dwordx4 v2, s[52:55], s67 offen lds
    s_add_u32 m0, s66, 3072
    s_mov_b32 s67, 24576
    buffer_load_dwordx4 v2, s[52:55], s67 offen lds
    s_add_u32 m0, s66, 4096
    s_mov_b32 s67, 32768
    buffer_load_dwordx4 v2, s[52:55], s67 offen lds
    s_add_u32 m0, s66, 5120
    s_mov_b32 s67, 40960
    buffer_load_dwordx4 v2, s[52:55], s67 offen lds
    s_waitcnt lgkmcnt(0)
    s_barrier
    s_waitcnt vmcnt(6)
    v_cmp_ne_u32 vcc, s46, v247
    s_cbranch_vccnz L_cold_30
L_back_31:
    buffer_load_dwordx4 v[160:163], v22, s[60:63], s90 offen offset:0 sc1
    buffer_load_dwordx4 v[164:167], v22, s[60:63], s90 offen offset:1024 sc1
    buffer_load_dwordx4 v[168:171], v22, s[60:63], s90 offen offset:2048 sc1
    buffer_load_dwordx4 v[172:175], v22, s[60:63], s90 offen offset:3072 sc1
    s_add_u32 m0, s66, 24576
    s_mov_b32 s67, 49152
    buffer_load_dwordx4 v2, s[52:55], s67 offen lds
    s_add_u32 m0, s66, 25600
    s_mov_b32 s67, 57344
    buffer_load_dwordx4 v2, s[52:55], s67 offen lds
    s_add_u32 m0, s66, 26624
    s_mov_b32 s67, 65536
    buffer_load_dwordx4 v2, s[52:55], s67 offen lds
    s_add_u32 m0, s66, 27648
    s_mov_b32 s67, 73728
    buffer_load_dwordx4 v2, s[52:55], s67 offen lds
    s_add_u32 m0, s66, 28672
    s_mov_b32 s67, 81920
    buffer_load_dwordx4 v2, s[52:55], s67 offen lds
    s_add_u32 m0, s66, 29696
    s_mov_b32 s67, 90112
    buffer_load_dwordx4 v2, s[52:55], s67 offen lds
L_Hjoin:
    s_cmp_eq_u32 s85, 0
    s_cselect_b64 exec, -1, 0
    ds_write_b32 v26, v176 offset:4088
    s_mov_b64 exec, -1
    ds_write_b128 v20, v[204:207] offset:16
    ds_write_b32 v20, v204 offset:8332
    ds_write_b32 v20, v207 offset:8344
    ds_write_b64 v20, v[212:213] offset:8336
    ds_write_b32 v20, v208 offset:4172
    ds_write_b32 v20, v211 offset:4184
    ds_write_b64 v20, v[208:209] offset:12488
    ds_write_b64 v20, v[210:211] offset:12496
    ds_write_b64 v20, v[214:215] offset:4176
    ds_write_b128 v21, v[216:219] offset:16
    ds_write_b32 v21, v216 offset:8332
    ds_write_b32 v21, v219 offset:8344
    ds_write_b64 v21, v[224:225] offset:8336
    ds_write_b32 v21, v220 offset:4172
    ds_write_b32 v21, v223 offset:4184
    ds_write_b64 v21, v[220:221] offset:12488
    ds_write_b64 v21, v[222:223] offset:12496
    ds_write_b64 v21, v[226:227] offset:4176
    v_mov_b32 v31, s68
    s_cselect_b64 exec, 1, 0
    ds_write_b16 v31, v27 offset:8252
    ds_write_b16 v31, v27 offset:16568
    s_mov_b64 exec, -1
    s_waitcnt lgkmcnt(0)
    v_mov_b32 v31, 1
    ds_write_b32 v29, v31 offset:4
    ds_write_b128 v249, v[176:179]
    ds_write_b128 v249, v[176:179] offset:3072
    s_waitcnt vmcnt(6)
    ds_write_b128 v248, v[160:163] offset:512
    ds_write_b128 v248, v[164:167] offset:768
    ds_write_b128 v248, v[168:171] offset:1024
    ds_write_b128 v248, v[172:175] offset:1280
    s_mov_b32 s47, 0
L_lw_33:
    ds_read_b32 v31, v30 offset:4
    s_waitcnt lgkmcnt(0)
    v_readfirstlane_b32 s70, v31
    s_cmp_eq_u32 s70, 1
    s_cselect_b32 s47, 1048576, s47
    s_add_u32 s47, s47, 1
    s_cmp_lt_u32 s47, 1048576
    s_cbranch_scc1 L_lw_33
    ds_read_b64 v[64:65], v18 offset:4032
    ds_read_b64 v[66:67], v18 offset:4040
    ds_read_b128 v[72:75], v19 offset:256
    ds_read_b128 v[76:79], v19 offset:768
    ds_read_b64 v[68:69], v18 offset:1984
    ds_read_b64 v[70:71], v18 offset:1992
    ds_read_b64 v[80:81], v18 offset:4064
    ds_read_b64 v[82:83], v18 offset:4072
    ds_read_b128 v[88:91], v19 offset:3328
    ds_read_b128 v[92:95], v19 offset:3840
    ds_read_b64 v[84:85], v18 offset:2016
    ds_read_b64 v[86:87], v18 offset:2024
    s_waitcnt lgkmcnt(6)
    ds_read_b64 v[96:97], v18 offset:3968
    ds_read_b64 v[98:99], v18 offset:3976
    ds_read_b128 v[104:107], v19 offset:240
    ds_read_b128 v[108:111], v19 offset:752
    ds_read_b64 v[100:101], v18 offset:1920
    ds_read_b64 v[102:103], v18 offset:1928
    v_mfma_f32_32x32x16_bf16 v[32:47], v[64:67], v[72:75], 0
    v_mfma_f32_32x32x16_bf16 v[48:63], v[64:67], v[76:79], 0
    v_mfma_f32_32x32x16_bf16 v[48:63], v[68:71], v[72:75], v[48:63]
    s_waitcnt lgkmcnt(6)
    ds_read_b64 v[64:65], v18 offset:4000
    ds_read_b64 v[66:67], v18 offset:4008
    ds_read_b128 v[72:75], v19 offset:3312
    ds_read_b128 v[76:79], v19 offset:3824
    ds_read_b64 v[68:69], v18 offset:1952
    ds_read_b64 v[70:71], v18 offset:1960
    v_mfma_f32_32x32x16_bf16 v[32:47], v[80:83], v[88:91], v[32:47]
    v_mfma_f32_32x32x16_bf16 v[48:63], v[80:83], v[92:95], v[48:63]
    v_mfma_f32_32x32x16_bf16 v[48:63], v[84:87], v[88:91], v[48:63]
    s_waitcnt lgkmcnt(6)
    ds_read_b64 v[80:81], v18 offset:3904
    ds_read_b64 v[82:83], v18 offset:3912
    ds_read_b128 v[88:91], v19 offset:224
    ds_read_b128 v[92:95], v19 offset:736
    ds_read_b64 v[84:85], v18 offset:1856
    ds_read_b64 v[86:87], v18 offset:1864
    v_mfma_f32_32x32x16_bf16 v[32:47], v[96:99], v[104:107], v[32:47]
    v_mfma_f32_32x32x16_bf16 v[48:63], v[96:99], v[108:111], v[48:63]
    v_mfma_f32_32x32x16_bf16 v[48:63], v[100:103], v[104:107], v[48:63]
    s_waitcnt lgkmcnt(6)
    ds_read_b64 v[96:97], v18 offset:3936
    ds_read_b64 v[98:99], v18 offset:3944
    ds_read_b128 v[104:107], v19 offset:3296
    ds_read_b128 v[108:111], v19 offset:3808
    ds_read_b64 v[100:101], v18 offset:1888
    ds_read_b64 v[102:103], v18 offset:1896
    v_mfma_f32_32x32x16_bf16 v[32:47], v[64:67], v[72:75], v[32:47]
    v_mfma_f32_32x32x16_bf16 v[48:63], v[64:67], v[76:79], v[48:63]
    v_mfma_f32_32x32x16_bf16 v[48:63], v[68:71], v[72:75], v[48:63]
    s_waitcnt lgkmcnt(6)
    ds_read_b64 v[64:65], v18 offset:3840
    ds_read_b64 v[66:67], v18 offset:3848
    ds_read_b128 v[72:75], v19 offset:208
    ds_read_b128 v[76:79], v19 offset:720
    ds_read_b64 v[68:69], v18 offset:1792
    ds_read_b64 v[70:71], v18 offset:1800
    v_mfma_f32_32x32x16_bf16 v[32:47], v[80:83], v[88:91], v[32:47]
    v_mfma_f32_32x32x16_bf16 v[48:63], v[80:83], v[92:95], v[48:63]
    v_mfma_f32_32x32x16_bf16 v[48:63], v[84:87], v[88:91], v[48:63]
    s_waitcnt lgkmcnt(6)
    ds_read_b64 v[80:81], v18 offset:3872
    ds_read_b64 v[82:83], v18 offset:3880
    ds_read_b128 v[88:91], v19 offset:3280
    ds_read_b128 v[92:95], v19 offset:3792
    ds_read_b64 v[84:85], v18 offset:1824
    ds_read_b64 v[86:87], v18 offset:1832
    v_mfma_f32_32x32x16_bf16 v[32:47], v[96:99], v[104:107], v[32:47]
    v_mfma_f32_32x32x16_bf16 v[48:63], v[96:99], v[108:111], v[48:63]
    v_mfma_f32_32x32x16_bf16 v[48:63], v[100:103], v[104:107], v[48:63]
    s_waitcnt lgkmcnt(6)
    s_waitcnt vmcnt(0)
    v_mov_b32 v31, 1
    ds_write_b32 v29, v31 offset:12
    ds_read_b64 v[96:97], v18 offset:3776
    ds_read_b64 v[98:99], v18 offset:3784
    ds_read_b128 v[104:107], v19 offset:192
    ds_read_b128 v[108:111], v19 offset:704
    ds_read_b64 v[100:101], v18 offset:1728
    ds_read_b64 v[102:103], v18 offset:1736
    v_mfma_f32_32x32x16_bf16 v[32:47], v[64:67], v[72:75], v[32:47]
    v_mfma_f32_32x32x16_bf16 v[48:63], v[64:67], v[76:79], v[48:63]
    v_mfma_f32_32x32x16_bf16 v[48:63], v[68:71], v[72:75], v[48:63]
    s_waitcnt lgkmcnt(7)
    ds_read_b64 v[64:65], v18 offset:3808
    ds_read_b64 v[66:67], v18 offset:3816
    ds_read_b128 v[72:75], v19 offset:3264
    ds_read_b128 v[76:79], v19 offset:3776
    ds_read_b64 v[68:69], v18 offset:1760
    ds_read_b64 v[70:71], v18 offset:1768
    v_mfma_f32_32x32x16_bf16 v[32:47], v[80:83], v[88:91], v[32:47]
    v_mfma_f32_32x32x16_bf16 v[48:63], v[80:83], v[92:95], v[48:63]
    v_mfma_f32_32x32x16_bf16 v[48:63], v[84:87], v[88:91], v[48:63]
    s_waitcnt lgkmcnt(6)
    ds_read_b64 v[80:81], v18 offset:3712
    ds_read_b64 v[82:83], v18 offset:3720
    ds_read_b128 v[88:91], v19 offset:176
    ds_read_b128 v[92:95], v19 offset:688
    ds_read_b64 v[84:85], v18 offset:1664
    ds_read_b64 v[86:87], v18 offset:1672
    v_mfma_f32_32x32x16_bf16 v[32:47], v[96:99], v[104:107], v[32:47]
    v_mfma_f32_32x32x16_bf16 v[48:63], v[96:99], v[108:111], v[48:63]
    v_mfma_f32_32x32x16_bf16 v[48:63], v[100:103], v[104:107], v[48:63]
    s_waitcnt lgkmcnt(6)
    ds_read_b64 v[96:97], v18 offset:3744
    ds_read_b64 v[98:99], v18 offset:3752
    ds_read_b128 v[104:107], v19 offset:3248
    ds_read_b128 v[108:111], v19 offset:3760
    ds_read_b64 v[100:101], v18 offset:1696
    ds_read_b64 v[102:103], v18 offset:1704
    v_mfma_f32_32x32x16_bf16 v[32:47], v[64:67], v[72:75], v[32:47]
    v_mfma_f32_32x32x16_bf16 v[48:63], v[64:67], v[76:79], v[48:63]
    v_mfma_f32_32x32x16_bf16 v[48:63], v[68:71], v[72:75], v[48:63]
    s_waitcnt lgkmcnt(6)
    ds_read_b64 v[64:65], v18 offset:3648
    ds_read_b64 v[66:67], v18 offset:3656
    ds_read_b128 v[72:75], v19 offset:160
    ds_read_b128 v[76:79], v19 offset:672
    ds_read_b64 v[68:69], v18 offset:1600
    ds_read_b64 v[70:71], v18 offset:1608
    v_mfma_f32_32x32x16_bf16 v[32:47], v[80:83], v[88:91], v[32:47]
    v_mfma_f32_32x32x16_bf16 v[48:63], v[80:83], v[92:95], v[48:63]
    v_mfma_f32_32x32x16_bf16 v[48:63], v[84:87], v[88:91], v[48:63]
    s_waitcnt lgkmcnt(6)
    ds_read_b64 v[80:81], v18 offset:3680
    ds_read_b64 v[82:83], v18 offset:3688
    ds_read_b128 v[88:91], v19 offset:3232
    ds_read_b128 v[92:95], v19 offset:3744
    ds_read_b64 v[84:85], v18 offset:1632
    ds_read_b64 v[86:87], v18 offset:1640
    v_mfma_f32_32x32x16_bf16 v[32:47], v[96:99], v[104:107], v[32:47]
    v_mfma_f32_32x32x16_bf16 v[48:63], v[96:99], v[108:111], v[48:63]
    v_mfma_f32_32x32x16_bf16 v[48:63], v[100:103], v[104:107], v[48:63]
    s_waitcnt lgkmcnt(6)
    ds_read_b64 v[96:97], v18 offset:3584
    ds_read_b64 v[98:99], v18 offset:3592
    ds_read_b128 v[104:107], v19 offset:144
    ds_read_b128 v[108:111], v19 offset:656
    ds_read_b64 v[100:101], v18 offset:1536
    ds_read_b64 v[102:103], v18 offset:1544
    v_mfma_f32_32x32x16_bf16 v[32:47], v[64:67], v[72:75], v[32:47]
    v_mfma_f32_32x32x16_bf16 v[48:63], v[64:67], v[76:79], v[48:63]
    v_mfma_f32_32x32x16_bf16 v[48:63], v[68:71], v[72:75], v[48:63]
    s_waitcnt lgkmcnt(6)
    ds_read_b64 v[64:65], v18 offset:3616
    ds_read_b64 v[66:67], v18 offset:3624
    ds_read_b128 v[72:75], v19 offset:3216
    ds_read_b128 v[76:79], v19 offset:3728
    ds_read_b64 v[68:69], v18 offset:1568
    ds_read_b64 v[70:71], v18 offset:1576
    v_mfma_f32_32x32x16_bf16 v[32:47], v[80:83], v[88:91], v[32:47]
    v_mfma_f32_32x32x16_bf16 v[48:63], v[80:83], v[92:95], v[48:63]
    v_mfma_f32_32x32x16_bf16 v[48:63], v[84:87], v[88:91], v[48:63]
    s_waitcnt lgkmcnt(6)
    ds_read_b64 v[80:81], v18 offset:3520
    ds_read_b64 v[82:83], v18 offset:3528
    ds_read_b128 v[88:91], v19 offset:128
    ds_read_b128 v[92:95], v19 offset:640
    ds_read_b64 v[84:85], v18 offset:1472
    ds_read_b64 v[86:87], v18 offset:1480
    v_mfma_f32_32x32x16_bf16 v[32:47], v[96:99], v[104:107], v[32:47]
    v_mfma_f32_32x32x16_bf16 v[48:63], v[96:99], v[108:111], v[48:63]
    v_mfma_f32_32x32x16_bf16 v[48:63], v[100:103], v[104:107], v[48:63]
    s_waitcnt lgkmcnt(6)
    ds_read_b64 v[96:97], v18 offset:3552
    ds_read_b64 v[98:99], v18 offset:3560
    ds_read_b128 v[104:107], v19 offset:3200
    ds_read_b128 v[108:111], v19 offset:3712
    ds_read_b64 v[100:101], v18 offset:1504
    ds_read_b64 v[102:103], v18 offset:1512
    v_mfma_f32_32x32x16_bf16 v[32:47], v[64:67], v[72:75], v[32:47]
    v_mfma_f32_32x32x16_bf16 v[48:63], v[64:67], v[76:79], v[48:63]
    v_mfma_f32_32x32x16_bf16 v[48:63], v[68:71], v[72:75], v[48:63]
    s_waitcnt lgkmcnt(6)
    ds_read_b64 v[64:65], v18 offset:3456
    ds_read_b64 v[66:67], v18 offset:3464
    ds_read_b128 v[72:75], v19 offset:112
    ds_read_b128 v[76:79], v19 offset:624
    ds_read_b64 v[68:69], v18 offset:1408
    ds_read_b64 v[70:71], v18 offset:1416
    v_mfma_f32_32x32x16_bf16 v[32:47], v[80:83], v[88:91], v[32:47]
    v_mfma_f32_32x32x16_bf16 v[48:63], v[80:83], v[92:95], v[48:63]
    v_mfma_f32_32x32x16_bf16 v[48:63], v[84:87], v[88:91], v[48:63]
    s_waitcnt lgkmcnt(6)
    ds_read_b64 v[80:81], v18 offset:3488
    ds_read_b64 v[82:83], v18 offset:3496
    ds_read_b128 v[88:91], v19 offset:3184
    ds_read_b128 v[92:95], v19 offset:3696
    ds_read_b64 v[84:85], v18 offset:1440
    ds_read_b64 v[86:87], v18 offset:1448
    v_mfma_f32_32x32x16_bf16 v[32:47], v[96:99], v[104:107], v[32:47]
    v_mfma_f32_32x32x16_bf16 v[48:63], v[96:99], v[108:111], v[48:63]
    v_mfma_f32_32x32x16_bf16 v[48:63], v[100:103], v[104:107], v[48:63]
    s_waitcnt lgkmcnt(6)
    ds_read_b64 v[96:97], v18 offset:3392
    ds_read_b64 v[98:99], v18 offset:3400
    ds_read_b128 v[104:107], v19 offset:96
    ds_read_b128 v[108:111], v19 offset:608
    ds_read_b64 v[100:101], v18 offset:1344
    ds_read_b64 v[102:103], v18 offset:1352
    v_mfma_f32_32x32x16_bf16 v[32:47], v[64:67], v[72:75], v[32:47]
    v_mfma_f32_32x32x16_bf16 v[48:63], v[64:67], v[76:79], v[48:63]
    v_mfma_f32_32x32x16_bf16 v[48:63], v[68:71], v[72:75], v[48:63]
    s_waitcnt lgkmcnt(6)
    ds_read_b64 v[64:65], v18 offset:3424
    ds_read_b64 v[66:67], v18 offset:3432
    ds_read_b128 v[72:75], v19 offset:3168
    ds_read_b128 v[76:79], v19 offset:3680
    ds_read_b64 v[68:69], v18 offset:1376
    ds_read_b64 v[70:71], v18 offset:1384
    v_mfma_f32_32x32x16_bf16 v[32:47], v[80:83], v[88:91], v[32:47]
    v_mfma_f32_32x32x16_bf16 v[48:63], v[80:83], v[92:95], v[48:63]
    v_mfma_f32_32x32x16_bf16 v[48:63], v[84:87], v[88:91], v[48:63]
    s_waitcnt lgkmcnt(6)
    ds_read_b64 v[80:81], v18 offset:3328
    ds_read_b64 v[82:83], v18 offset:3336
    ds_read_b128 v[88:91], v19 offset:80
    ds_read_b128 v[92:95], v19 offset:592
    ds_read_b64 v[84:85], v18 offset:1280
    ds_read_b64 v[86:87], v18 offset:1288
    v_mfma_f32_32x32x16_bf16 v[32:47], v[96:99], v[104:107], v[32:47]
    v_mfma_f32_32x32x16_bf16 v[48:63], v[96:99], v[108:111], v[48:63]
    v_mfma_f32_32x32x16_bf16 v[48:63], v[100:103], v[104:107], v[48:63]
    s_waitcnt lgkmcnt(6)
    ds_read_b64 v[96:97], v18 offset:3360
    ds_read_b64 v[98:99], v18 offset:3368
    ds_read_b128 v[104:107], v19 offset:3152
    ds_read_b128 v[108:111], v19 offset:3664
    ds_read_b64 v[100:101], v18 offset:1312
    ds_read_b64 v[102:103], v18 offset:1320
    v_mfma_f32_32x32x16_bf16 v[32:47], v[64:67], v[72:75], v[32:47]
    v_mfma_f32_32x32x16_bf16 v[48:63], v[64:67], v[76:79], v[48:63]
    v_mfma_f32_32x32x16_bf16 v[48:63], v[68:71], v[72:75], v[48:63]
    s_waitcnt lgkmcnt(6)
    ds_read_b64 v[64:65], v18 offset:3264
    ds_read_b64 v[66:67], v18 offset:3272
    ds_read_b128 v[72:75], v19 offset:64
    ds_read_b128 v[76:79], v19 offset:576
    ds_read_b64 v[68:69], v18 offset:1216
    ds_read_b64 v[70:71], v18 offset:1224
    v_mfma_f32_32x32x16_bf16 v[32:47], v[80:83], v[88:91], v[32:47]
    v_mfma_f32_32x32x16_bf16 v[48:63], v[80:83], v[92:95], v[48:63]
    v_mfma_f32_32x32x16_bf16 v[48:63], v[84:87], v[88:91], v[48:63]
    s_waitcnt lgkmcnt(6)
    ds_read_b64 v[80:81], v18 offset:3296
    ds_read_b64 v[82:83], v18 offset:3304
    ds_read_b128 v[88:91], v19 offset:3136
    ds_read_b128 v[92:95], v19 offset:3648
    ds_read_b64 v[84:85], v18 offset:1248
    ds_read_b64 v[86:87], v18 offset:1256
    v_mfma_f32_32x32x16_bf16 v[32:47], v[96:99], v[104:107], v[32:47]
    v_mfma_f32_32x32x16_bf16 v[48:63], v[96:99], v[108:111], v[48:63]
    v_mfma_f32_32x32x16_bf16 v[48:63], v[100:103], v[104:107], v[48:63]
    s_waitcnt lgkmcnt(6)
    ds_read_b64 v[96:97], v18 offset:3200
    ds_read_b64 v[98:99], v18 offset:3208
    ds_read_b128 v[104:107], v19 offset:48
    ds_read_b128 v[108:111], v19 offset:560
    ds_read_b64 v[100:101], v18 offset:1152
    ds_read_b64 v[102:103], v18 offset:1160
    v_mfma_f32_32x32x16_bf16 v[32:47], v[64:67], v[72:75], v[32:47]
    v_mfma_f32_32x32x16_bf16 v[48:63], v[64:67], v[76:79], v[48:63]
    v_mfma_f32_32x32x16_bf16 v[48:63], v[68:71], v[72:75], v[48:63]
    s_waitcnt lgkmcnt(6)
    ds_read_b64 v[64:65], v18 offset:3232
    ds_read_b64 v[66:67], v18 offset:3240
    ds_read_b128 v[72:75], v19 offset:3120
    ds_read_b128 v[76:79], v19 offset:3632
    ds_read_b64 v[68:69], v18 offset:1184
    ds_read_b64 v[70:71], v18 offset:1192
    v_mfma_f32_32x32x16_bf16 v[32:47], v[80:83], v[88:91], v[32:47]
    v_mfma_f32_32x32x16_bf16 v[48:63], v[80:83], v[92:95], v[48:63]
    v_mfma_f32_32x32x16_bf16 v[48:63], v[84:87], v[88:91], v[48:63]
    s_waitcnt lgkmcnt(6)
    ds_read_b64 v[80:81], v18 offset:3136
    ds_read_b64 v[82:83], v18 offset:3144
    ds_read_b128 v[88:91], v19 offset:32
    ds_read_b128 v[92:95], v19 offset:544
    ds_read_b64 v[84:85], v18 offset:1088
    ds_read_b64 v[86:87], v18 offset:1096
    v_mfma_f32_32x32x16_bf16 v[32:47], v[96:99], v[104:107], v[32:47]
    v_mfma_f32_32x32x16_bf16 v[48:63], v[96:99], v[108:111], v[48:63]
    v_mfma_f32_32x32x16_bf16 v[48:63], v[100:103], v[104:107], v[48:63]
    s_waitcnt lgkmcnt(6)
    ds_read_b64 v[96:97], v18 offset:3168
    ds_read_b64 v[98:99], v18 offset:3176
    ds_read_b128 v[104:107], v19 offset:3104
    ds_read_b128 v[108:111], v19 offset:3616
    ds_read_b64 v[100:101], v18 offset:1120
    ds_read_b64 v[102:103], v18 offset:1128
    v_mfma_f32_32x32x16_bf16 v[32:47], v[64:67], v[72:75], v[32:47]
    v_mfma_f32_32x32x16_bf16 v[48:63], v[64:67], v[76:79], v[48:63]
    v_mfma_f32_32x32x16_bf16 v[48:63], v[68:71], v[72:75], v[48:63]
    s_waitcnt lgkmcnt(6)
    ds_read_b64 v[64:65], v18 offset:3072
    ds_read_b64 v[66:67], v18 offset:3080
    ds_read_b128 v[72:75], v19 offset:16
    ds_read_b128 v[76:79], v19 offset:528
    ds_read_b64 v[68:69], v18 offset:1024
    ds_read_b64 v[70:71], v18 offset:1032
    v_mfma_f32_32x32x16_bf16 v[32:47], v[80:83], v[88:91], v[32:47]
    v_mfma_f32_32x32x16_bf16 v[48:63], v[80:83], v[92:95], v[48:63]
    v_mfma_f32_32x32x16_bf16 v[48:63], v[84:87], v[88:91], v[48:63]
    s_waitcnt lgkmcnt(6)
    ds_read_b64 v[80:81], v18 offset:3104
    ds_read_b64 v[82:83], v18 offset:3112
    ds_read_b128 v[88:91], v19 offset:3088
    ds_read_b128 v[92:95], v19 offset:3600
    ds_read_b64 v[84:85], v18 offset:1056
    ds_read_b64 v[86:87], v18 offset:1064
    v_mfma_f32_32x32x16_bf16 v[32:47], v[96:99], v[104:107], v[32:47]
    v_mfma_f32_32x32x16_bf16 v[48:63], v[96:99], v[108:111], v[48:63]
    v_mfma_f32_32x32x16_bf16 v[48:63], v[100:103], v[104:107], v[48:63]
    s_waitcnt lgkmcnt(6)
    v_mfma_f32_32x32x16_bf16 v[32:47], v[64:67], v[72:75], v[32:47]
    v_mfma_f32_32x32x16_bf16 v[48:63], v[64:67], v[76:79], v[48:63]
    v_mfma_f32_32x32x16_bf16 v[48:63], v[68:71], v[72:75], v[48:63]
    s_waitcnt lgkmcnt(0)
    v_mfma_f32_32x32x16_bf16 v[32:47], v[80:83], v[88:91], v[32:47]
    v_mfma_f32_32x32x16_bf16 v[48:63], v[80:83], v[92:95], v[48:63]
    v_mfma_f32_32x32x16_bf16 v[48:63], v[84:87], v[88:91], v[48:63]
    s_setprio 3
    v_lshlrev_b32 v26, 4, v16
    v_lshl_add_u32 v26, v17, 3, v26
    s_lshl_b32 s70, s85, 9
    s_add_u32 s70, s70, s71
    v_add_u32 v26, s70, v26
    ds_read_b64 v[64:65], v26 offset:512
    ds_read_b64 v[66:67], v26 offset:2048
    ds_read_b64 v[68:69], v26 offset:3584
    ds_read_b64 v[70:71], v26 offset:5120
    s_mov_b32 s47, 0
L_mr_34:
    ds_read_b128 v[180:183], v28
    s_waitcnt lgkmcnt(0)
    v_and_b32 v180, v180, v181
    v_and_b32 v182, v182, v183
    v_and_b32 v180, v180, v182
    s_nop 0
    v_readfirstlane_b32 s70, v180
    s_cmp_eq_u32 s70, 1
    s_cselect_b32 s47, 1048576, s47
    s_add_u32 s47, s47, 1
    s_cmp_lt_u32 s47, 1048576
    s_cbranch_scc1 L_mr_34
    s_cmp_eq_u32 s85, 1
    s_cselect_b64 exec, -1, 0
    v_swap_b32 v32, v48
    v_swap_b32 v33, v49
    v_swap_b32 v34, v50
    v_swap_b32 v35, v51
    v_swap_b32 v36, v52
    v_swap_b32 v37, v53
    v_swap_b32 v38, v54
    v_swap_b32 v39, v55
    v_swap_b32 v40, v56
    v_swap_b32 v41, v57
    v_swap_b32 v42, v58
    v_swap_b32 v43, v59
    v_swap_b32 v44, v60
    v_swap_b32 v45, v61
    v_swap_b32 v46, v62
    v_swap_b32 v47, v63
    s_mov_b64 exec, -1
    ds_write_b128 v24, v[48:51] offset:0
    ds_write_b128 v24, v[52:55] offset:1024
    ds_write_b128 v24, v[56:59] offset:2048
    ds_write_b128 v24, v[60:63] offset:3072
    s_waitcnt lgkmcnt(0)
    v_mov_b32 v31, 1
    ds_write_b32 v29, v31 offset:8
    v_lshlrev_b32 v80, 16, v64
    v_and_b32 v81, 0xffff0000, v64
    v_lshlrev_b32 v82, 16, v65
    v_and_b32 v83, 0xffff0000, v65
    v_lshlrev_b32 v84, 16, v66
    v_and_b32 v85, 0xffff0000, v66
    v_lshlrev_b32 v86, 16, v67
    v_and_b32 v87, 0xffff0000, v67
    v_lshlrev_b32 v88, 16, v68
    v_and_b32 v89, 0xffff0000, v68
    v_lshlrev_b32 v90, 16, v69
    v_and_b32 v91, 0xffff0000, v69
    v_lshlrev_b32 v92, 16, v70
    v_and_b32 v93, 0xffff0000, v70
    v_lshlrev_b32 v94, 16, v71
    v_and_b32 v95, 0xffff0000, v71
    v_mul_f32 v80, v239, v80
    v_mul_f32 v81, v239, v81
    v_mul_f32 v82, v239, v82
    v_mul_f32 v83, v239, v83
    v_mul_f32 v84, v239, v84
    v_mul_f32 v85, v239, v85
    v_mul_f32 v86, v239, v86
    v_mul_f32 v87, v239, v87
    v_mul_f32 v88, v239, v88
    v_mul_f32 v89, v239, v89
    v_mul_f32 v90, v239, v90
    v_mul_f32 v91, v239, v91
    v_mul_f32 v92, v239, v92
    v_mul_f32 v93, v239, v93
    v_mul_f32 v94, v239, v94
    v_mul_f32 v95, v239, v95
    v_cvt_pk_bf16_f32 v64, v80, v81
    v_cvt_pk_bf16_f32 v65, v82, v83
    v_cvt_pk_bf16_f32 v66, v84, v85
    v_cvt_pk_bf16_f32 v67, v86, v87
    v_cvt_pk_bf16_f32 v68, v88, v89
    v_cvt_pk_bf16_f32 v69, v90, v91
    v_cvt_pk_bf16_f32 v70, v92, v93
    v_cvt_pk_bf16_f32 v71, v94, v95
    v_lshlrev_b32 v80, 16, v64
    v_and_b32 v81, 0xffff0000, v64
    v_lshlrev_b32 v82, 16, v65
    v_and_b32 v83, 0xffff0000, v65
    v_lshlrev_b32 v84, 16, v66
    v_and_b32 v85, 0xffff0000, v66
    v_lshlrev_b32 v86, 16, v67
    v_and_b32 v87, 0xffff0000, v67
    v_lshlrev_b32 v88, 16, v68
    v_and_b32 v89, 0xffff0000, v68
    v_lshlrev_b32 v90, 16, v69
    v_and_b32 v91, 0xffff0000, v69
    v_lshlrev_b32 v92, 16, v70
    v_and_b32 v93, 0xffff0000, v70
    v_lshlrev_b32 v94, 16, v71
    v_and_b32 v95, 0xffff0000, v71
    v_lshlrev_b32 v26, 6, v16
    v_lshl_add_u32 v26, v17, 3, v26
    v_add_u32 v26, s71, v26
    s_lshl_b32 s74, s86, 12
    s_lshl_b32 s73, s85, 11
    s_add_u32 s74, s74, s73
    s_add_u32 s74, s74, 10485760
    s_lshr_b32 s72, s86, 6
    s_lshl_b32 s72, s72, 7
    s_lshl_b32 s73, s85, 6
    s_add_u32 s72, s72, s73
    s_and_b32 s73, s86, 63
    s_add_u32 s72, s72, s73
    s_lshl_b32 s72, s72, 7
    s_add_u32 s72, s72, 12943360
    s_mov_b32 s47, 0
L_lw_35:
    ds_read_b32 v31, v30 offset:8
    s_waitcnt lgkmcnt(0)
    v_readfirstlane_b32 s70, v31
    s_cmp_eq_u32 s70, 1
    s_cselect_b32 s47, 1048576, s47
    s_add_u32 s47, s47, 1
    s_cmp_lt_u32 s47, 1048576
    s_cbranch_scc1 L_lw_35
    ds_read_b128 v[48:51], v25 offset:0
    ds_read_b128 v[52:55], v25 offset:1024
    ds_read_b128 v[56:59], v25 offset:2048
    ds_read_b128 v[60:63], v25 offset:3072
    s_waitcnt lgkmcnt(0)
    v_add_f32 v32, v32, v48
    v_add_f32 v33, v33, v49
    v_add_f32 v34, v34, v50
    v_add_f32 v35, v35, v51
    v_add_f32 v36, v36, v52
    v_add_f32 v37, v37, v53
    v_add_f32 v38, v38, v54
    v_add_f32 v39, v39, v55
    v_add_f32 v40, v40, v56
    v_add_f32 v41, v41, v57
    v_add_f32 v42, v42, v58
    v_add_f32 v43, v43, v59
    v_add_f32 v44, v44, v60
    v_add_f32 v45, v45, v61
    v_add_f32 v46, v46, v62
    v_add_f32 v47, v47, v63
    v_cvt_pk_bf16_f32 v48, v32, v33
    v_cvt_pk_bf16_f32 v49, v34, v35
    v_cvt_pk_bf16_f32 v50, v36, v37
    v_cvt_pk_bf16_f32 v51, v38, v39
    v_cvt_pk_bf16_f32 v52, v40, v41
    v_cvt_pk_bf16_f32 v53, v42, v43
    v_cvt_pk_bf16_f32 v54, v44, v45
    v_cvt_pk_bf16_f32 v55, v46, v47
    v_lshlrev_b32 v32, 16, v48
    v_and_b32 v33, 0xffff0000, v48
    v_lshlrev_b32 v34, 16, v49
    v_and_b32 v35, 0xffff0000, v49
    v_lshlrev_b32 v36, 16, v50
    v_and_b32 v37, 0xffff0000, v50
    v_lshlrev_b32 v38, 16, v51
    v_and_b32 v39, 0xffff0000, v51
    v_lshlrev_b32 v40, 16, v52
    v_and_b32 v41, 0xffff0000, v52
    v_lshlrev_b32 v42, 16, v53
    v_and_b32 v43, 0xffff0000, v53
    v_lshlrev_b32 v44, 16, v54
    v_and_b32 v45, 0xffff0000, v54
    v_lshlrev_b32 v46, 16, v55
    v_and_b32 v47, 0xffff0000, v55
    v_add_f32 v32, v32, v80
    v_add_f32 v33, v33, v81
    v_add_f32 v34, v34, v82
    v_add_f32 v35, v35, v83
    v_add_f32 v36, v36, v84
    v_add_f32 v37, v37, v85
    v_add_f32 v38, v38, v86
    v_add_f32 v39, v39, v87
    v_add_f32 v40, v40, v88
    v_add_f32 v41, v41, v89
    v_add_f32 v42, v42, v90
    v_add_f32 v43, v43, v91
    v_add_f32 v44, v44, v92
    v_add_f32 v45, v45, v93
    v_add_f32 v46, v46, v94
    v_add_f32 v47, v47, v95
    v_cvt_pk_bf16_f32 v48, v32, v33
    v_cvt_pk_bf16_f32 v49, v34, v35
    v_cvt_pk_bf16_f32 v50, v36, v37
    v_cvt_pk_bf16_f32 v51, v38, v39
    v_cvt_pk_bf16_f32 v52, v40, v41
    v_cvt_pk_bf16_f32 v53, v42, v43
    v_cvt_pk_bf16_f32 v54, v44, v45
    v_cvt_pk_bf16_f32 v55, v46, v47
    ds_write_b64 v26, v[48:49] offset:0
    ds_write_b64 v26, v[50:51] offset:16
    ds_write_b64 v26, v[52:53] offset:32
    ds_write_b64 v26, v[54:55] offset:48
    ds_read_b128 v[64:67], v23 offset:0
    ds_read_b128 v[68:71], v23 offset:1024
    s_waitcnt lgkmcnt(0)
    buffer_store_dwordx4 v[64:67], v22, s[60:63], s74 offen offset:0 sc1
    buffer_store_dwordx4 v[68:71], v22, s[60:63], s74 offen offset:1024 sc1
    s_waitcnt vmcnt(0)
    v_mov_b32 v16, s46
    v_lshlrev_b32 v17, 2, v1
    s_mov_b32 exec_hi, 0
    buffer_store_dword v16, v17, s[60:63], s72 offen sc1
    s_mov_b32 exec_hi, -1
    s_endpgm
L_Haux:
    s_cmp_lg_u32 s2, 0
    s_cbranch_scc1 L_notag_36
    s_cmp_lg_u32 s45, 3
    s_cbranch_scc1 L_notag_36
    s_memrealtime s[74:75]
    s_waitcnt lgkmcnt(0)
    s_or_b32 s74, s74, 1
    v_mov_b32 v16, s74
    v_mov_b32 v17, 0
    s_mov_b64 exec, 1
    global_store_dword v17, v16, s[34:35] sc1
    s_mov_b64 exec, -1
L_notag_36:
    s_mul_i32 s68, s84, 17408
    s_add_u32 s68, s68, 1024
    s_lshl_b32 s70, s45, 4
    s_add_u32 s70, s70, 0
    v_mov_b32 v29, s70
    v_xor_b32 v30, 16, v29
    v_mov_b32 v176, 0
    v_mov_b32 v177, 0
    v_mov_b32 v178, 0
    v_mov_b32 v179, 0
    ds_write_b128 v29, v[176:179]
    v_mov_b32 v28, 64
    v_lshlrev_b32 v22, 4, v1
    s_lshl_b32 s78, s45, 12
    s_add_u32 s78, s78, 139264
    v_add_u32 v24, s78, v22
    v_xor_b32 v25, 0x1000, v24
    s_mul_i32 s71, s45, 6144
    s_add_u32 s71, s71, 40960
    v_add_u32 v23, s71, v22
    v_mov_b32 v8, 1
    v_mov_b32 v9, 1
    v_mov_b32 v10, 1
    v_mov_b32 v11, 1
    ds_write_b128 v28, v[8:11] offset:32
    ds_write_b128 v28, v[8:11]
    s_waitcnt vmcnt(0) lgkmcnt(0)
    s_branch L_kgen
L_Haux_ret:
    v_mov_b32 v245, 0
    global_load_dword v244, v245, s[34:35] sc1
    s_waitcnt lgkmcnt(0)
    s_barrier
    s_lshl_b32 s70, s39, 2
    s_add_u32 s70, s70, s40
    s_lshl_b32 s70, s70, 2
    s_add_u32 s70, s70, s45
    s_mul_i32 s70, s70, 112
    v_min_u32 v5, 55, v1
    v_add_u32 v5, s70, v5
    v_lshlrev_b32 v5, 7, v5
    global_load_dword v252, v5, s[28:29]
    v_add_u32 v5, 7168, v5
    global_load_dword v252, v5, s[28:29]
    v_add_u32 v16, s68, v22
    ds_read_b128 v[128:131], v16 offset:0
    ds_read_b128 v[132:135], v16 offset:1024
    ds_read_b128 v[136:139], v16 offset:2048
    ds_read_b128 v[140:143], v16 offset:3072
    ds_read_b128 v[104:107], v16 offset:8704
    ds_read_b128 v[108:111], v16 offset:9728
    ds_read_b128 v[112:115], v16 offset:10752
    ds_read_b128 v[116:119], v16 offset:11776
    s_waitcnt lgkmcnt(0)
    v_add_f32 v128, v128, v104
    v_add_f32 v129, v129, v105
    v_add_f32 v130, v130, v106
    v_add_f32 v131, v131, v107
    v_add_f32 v132, v132, v108
    v_add_f32 v133, v133, v109
    v_add_f32 v134, v134, v110
    v_add_f32 v135, v135, v111
    v_add_f32 v136, v136, v112
    v_add_f32 v137, v137, v113
    v_add_f32 v138, v138, v114
    v_add_f32 v139, v139, v115
    v_add_f32 v140, v140, v116
    v_add_f32 v141, v141, v117
    v_add_f32 v142, v142, v118
    v_add_f32 v143, v143, v119
    s_waitcnt lgkmcnt(0)
    v_mov_b32 v31, 1
    ds_write_b32 v29, v31 offset:0
    s_waitcnt vmcnt(2)
    v_readfirstlane_b32 s46, v244
    s_cmp_lg_u32 s46, 0
    s_cbranch_scc0 L_cold_37
L_back_38:
    v_mov_b32 v245, 80
    v_mov_b32 v244, s46
    ds_write_b32 v245, v244
    v_and_b32 v246, 31, v1
    v_lshlrev_b32 v246, 7, v246
    s_lshr_b32 s79, s86, 7
    s_lshl_b32 s79, s79, 12
    s_add_u32 s79, s79, 12910592
    s_lshl_b32 s90, s86, 12
    s_add_u32 s90, s90, 8388608
    buffer_load_dword v247, v246, s[60:63], s79 offen sc1
    v_and_b32 v16, 15, v1
    v_lshrrev_b32 v17, 4, v1
    v_and_b32 v18, 1, v16
    v_cmp_eq_u32 vcc, 0, v18
    s_nop 1
    v_cndmask_b32 v144, v141, v140, vcc
    v_cndmask_b32 v145, v143, v142, vcc
    s_cmp_eq_u32 s85, 0
    s_cselect_b64 vcc, -1, 0
    v_cndmask_b32 v184, v140, v128, vcc
    v_cndmask_b32 v185, v140, v129, vcc
    v_cndmask_b32 v186, v140, v130, vcc
    v_cndmask_b32 v187, v140, v131, vcc
    v_cndmask_b32 v188, v144, v132, vcc
    v_cndmask_b32 v189, v141, v133, vcc
    v_cndmask_b32 v190, v141, v134, vcc
    v_cndmask_b32 v191, v141, v135, vcc
    v_cndmask_b32 v192, v141, v136, vcc
    v_cndmask_b32 v193, v142, v137, vcc
    v_cndmask_b32 v194, v142, v137, vcc
    v_cndmask_b32 v195, v142, v137, vcc
    v_cndmask_b32 v196, v142, v138, vcc
    v_cndmask_b32 v197, v145, v138, vcc
    v_cndmask_b32 v198, v143, v138, vcc
    v_cndmask_b32 v199, v143, v139, vcc
    v_cndmask_b32 v200, v143, v139, vcc
    v_cndmask_b32 v201, v143, v139, vcc
    v_lshlrev_b32 v19, 4, v16
    v_sub_u32 v19, 4064, v19
    v_add_u32 v19, s68, v19
    s_add_u32 s70, s85, 8
    v_lshlrev_b32 v20, s70, v17
    v_sub_u32 v20, v19, v20
    s_lshl_b32 s70, s85, 11
    v_subrev_u32 v20, s70, v20
    s_cmp_eq_u32 s85, 0
    s_cselect_b32 s70, 4, 1
    s_lshl_b32 s70, s70, 8
    v_subrev_u32 v21, s70, v20
    v_mul_u32_u24 v26, 4160, v17
    v_lshl_add_u32 v26, v16, 2, v26
    v_add_u32 v26, s68, v26
    v_cvt_pk_bf16_f32 v204, v191, v190
    v_cvt_pk_bf16_f32 v205, v189, v188
    v_cvt_pk_bf16_f32 v206, v187, v186
    v_cvt_pk_bf16_f32 v207, v185, v184
    v_cvt_pk_bf16_f32 v208, v192, v191
    v_cvt_pk_bf16_f32 v209, v190, v189
    v_cvt_pk_bf16_f32 v210, v188, v187
    v_cvt_pk_bf16_f32 v211, v186, v185
    v_mov_b32 v212, v205
    v_mov_b32 v213, v206
    v_mov_b32 v214, v209
    v_mov_b32 v215, v210
    v_cvt_pk_bf16_f32 v216, v200, v199
    v_cvt_pk_bf16_f32 v217, v198, v197
    v_cvt_pk_bf16_f32 v218, v196, v195
    v_cvt_pk_bf16_f32 v219, v194, v193
    v_cvt_pk_bf16_f32 v220, v201, v200
    v_cvt_pk_bf16_f32 v221, v199, v198
    v_cvt_pk_bf16_f32 v222, v197, v196
    v_cvt_pk_bf16_f32 v223, v195, v194
    v_mov_b32 v224, v217
    v_mov_b32 v225, v218
    v_mov_b32 v226, v221
    v_mov_b32 v227, v222
    v_cvt_pk_bf16_f32 v27, v128, v128
    v_and_b32 v16, 31, v1
    v_lshrrev_b32 v17, 5, v1
    v_mul_u32_u24 v249, 1536, v17
    v_lshl_add_u32 v249, v16, 4, v249
    v_add_u32 v249, s71, v249
    v_sub_u32 v18, 3, v16
    v_and_b32 v18, 3, v18
    v_mul_u32_u24 v18, 4158, v18
    v_sub_u32 v19, 31, v16
    v_lshl_add_u32 v19, v17, 3, v19
    v_lshl_add_u32 v18, v19, 1, v18
    s_lshl_b32 s70, s85, 10
    s_sub_u32 s70, s68, s70
    v_add_u32 v18, s70, v18
    s_lshl_b32 s70, s85, 8
    s_sub_u32 s70, 256, s70
    v_add_u32 v19, s70, v249
    v_and_b32 v248, 3, v1
    v_mul_u32_u24 v248, 1536, v248
    v_lshrrev_b32 v5, 2, v1
    v_lshl_add_u32 v248, v5, 4, v248
    v_add_u32 v248, s71, v248
    s_waitcnt vmcnt(0)
    v_cmp_ne_u32 vcc, s46, v247
    s_cbranch_vccnz L_cold_40
L_back_41:
    buffer_load_dwordx4 v[160:163], v22, s[60:63], s90 offen offset:0 sc1
    buffer_load_dwordx4 v[164:167], v22, s[60:63], s90 offen offset:1024 sc1
    buffer_load_dwordx4 v[168:171], v22, s[60:63], s90 offen offset:2048 sc1
    buffer_load_dwordx4 v[172:175], v22, s[60:63], s90 offen offset:3072 sc1
    s_mov_b32 s47, 0
L_lw_43:
    ds_read_b32 v31, v30 offset:0
    s_waitcnt lgkmcnt(0)
    v_readfirstlane_b32 s70, v31
    s_cmp_eq_u32 s70, 1
    s_cselect_b32 s47, 1048576, s47
    s_add_u32 s47, s47, 1
    s_cmp_lt_u32 s47, 1048576
    s_cbranch_scc1 L_lw_43
    s_waitcnt vmcnt(0)
    s_branch L_Hjoin
L_Maux:
    s_mov_b32 s48, s4
    s_mov_b32 s49, s5
    s_mov_b32 s50, 0x200000
    s_mov_b32 s51, 0x20000
    s_lshl_b32 s76, s39, 2
    s_add_u32 s76, s76, s40
    v_lshrrev_b32 v22, 4, v1
    v_bfe_u32 v23, v1, 1, 3
    v_xor_b32 v23, v23, v22
    v_lshlrev_b32 v10, 10, v22
    v_lshl_add_u32 v10, v23, 5, v10
    v_and_b32 v23, 1, v1
    v_lshl_add_u32 v10, v23, 4, v10
    v_xor_b32 v11, 0x80, v10
    s_lshl_b32 s77, s45, 8
    v_add_u32 v10, s77, v10
    v_add_u32 v11, s77, v11
    s_lshl_b32 s77, s76, 16
    s_lshl_b32 s78, s45, 14
    s_add_u32 s78, s78, 65536
    s_add_u32 m0, s78, 0
    s_add_u32 s79, s77, 0
    buffer_load_dwordx4 v10, s[48:51], s79 offen lds
    s_add_u32 m0, s78, 1024
    s_add_u32 s79, s77, 4096
    buffer_load_dwordx4 v10, s[48:51], s79 offen lds
    s_add_u32 m0, s78, 2048
    s_add_u32 s79, s77, 8192
    buffer_load_dwordx4 v11, s[48:51], s79 offen lds
    s_add_u32 m0, s78, 3072
    s_add_u32 s79, s77, 12288
    buffer_load_dwordx4 v11, s[48:51], s79 offen lds
    s_add_u32 m0, s78, 4096
    s_add_u32 s79, s77, 16384
    buffer_load_dwordx4 v10, s[48:51], s79 offen lds
    s_add_u32 m0, s78, 5120
    s_add_u32 s79, s77, 20480
    buffer_load_dwordx4 v10, s[48:51], s79 offen lds
    s_add_u32 m0, s78, 6144
    s_add_u32 s79, s77, 24576
    buffer_load_dwordx4 v11, s[48:51], s79 offen lds
    s_add_u32 m0, s78, 7168
    s_add_u32 s79, s77, 28672
    buffer_load_dwordx4 v11, s[48:51], s79 offen lds
    s_add_u32 m0, s78, 8192
    s_add_u32 s79, s77, 32768
    buffer_load_dwordx4 v10, s[48:51], s79 offen lds
    s_add_u32 m0, s78, 9216
    s_add_u32 s79, s77, 36864
    buffer_load_dwordx4 v10, s[48:51], s79 offen lds
    s_add_u32 m0, s78, 10240
    s_add_u32 s79, s77, 40960
    buffer_load_dwordx4 v11, s[48:51], s79 offen lds
    s_add_u32 m0, s78, 11264
    s_add_u32 s79, s77, 45056
    buffer_load_dwordx4 v11, s[48:51], s79 offen lds
    s_add_u32 m0, s78, 12288
    s_add_u32 s79, s77, 49152
    buffer_load_dwordx4 v10, s[48:51], s79 offen lds
    s_add_u32 m0, s78, 13312
    s_add_u32 s79, s77, 53248
    buffer_load_dwordx4 v10, s[48:51], s79 offen lds
    s_add_u32 m0, s78, 14336
    s_add_u32 s79, s77, 57344
    buffer_load_dwordx4 v11, s[48:51], s79 offen lds
    s_add_u32 m0, s78, 15360
    s_add_u32 s79, s77, 61440
    buffer_load_dwordx4 v11, s[48:51], s79 offen lds
    v_lshlrev_b32 v12, 4, v22
    v_bfe_u32 v23, v1, 2, 2
    v_lshl_add_u32 v24, v22, 3, v23
    v_lshlrev_b32 v13, 8, v24
    v_and_b32 v24, 1, v22
    v_lshl_add_u32 v24, v24, 2, v23
    v_lshl_add_u32 v13, v24, 5, v13
    v_and_b32 v24, 3, v1
    v_lshl_add_u32 v13, v24, 3, v13
    v_add_u32 v13, s78, v13
    v_and_b32 v25, 15, v1
    s_lshl_b32 s83, s76, 7
    s_add_u32 s83, s83, 8388608
    s_lshl_b32 s79, s45, 11
    s_add_u32 s79, s79, 131072
    v_and_b32 v19, 7, v25
    v_xor_b32 v19, v19, v22
    v_lshlrev_b32 v16, 7, v25
    v_lshl_add_u32 v16, v19, 4, v16
    v_add_u32 v16, s79, v16
    v_xor_b32 v20, 64, v16
    v_add_u32 v17, s79, v8
    v_lshrrev_b32 v18, 3, v1
    v_and_b32 v19, 7, v1
    v_xor_b32 v19, v19, v18
    s_lshl_b32 s79, s45, 7
    v_add_u32 v18, s79, v18
    v_lshlrev_b32 v18, 12, v18
    v_lshl_add_u32 v18, v19, 4, v18
    s_waitcnt vmcnt(0)
    v_mov_b32 v27, 0
    global_load_dword v26, v27, s[34:35] sc1
    v_xor_b32 v15, 0, v13
    ds_read_b64_tr_b16 v[160:161], v15 offset:0
    ds_read_b64_tr_b16 v[162:163], v15 offset:1024
    ds_read_b64_tr_b16 v[164:165], v15 offset:8192
    ds_read_b64_tr_b16 v[166:167], v15 offset:9216
    v_xor_b32 v15, 32, v13
    ds_read_b64_tr_b16 v[168:169], v15 offset:0
    ds_read_b64_tr_b16 v[170:171], v15 offset:1024
    ds_read_b64_tr_b16 v[172:173], v15 offset:8192
    ds_read_b64_tr_b16 v[174:175], v15 offset:9216
    v_xor_b32 v15, 64, v13
    ds_read_b64_tr_b16 v[176:177], v15 offset:0
    ds_read_b64_tr_b16 v[178:179], v15 offset:1024
    ds_read_b64_tr_b16 v[180:181], v15 offset:8192
    ds_read_b64_tr_b16 v[182:183], v15 offset:9216
    v_xor_b32 v15, 96, v13
    ds_read_b64_tr_b16 v[184:185], v15 offset:0
    ds_read_b64_tr_b16 v[186:187], v15 offset:1024
    ds_read_b64_tr_b16 v[188:189], v15 offset:8192
    ds_read_b64_tr_b16 v[190:191], v15 offset:9216
    v_xor_b32 v15, 128, v13
    ds_read_b64_tr_b16 v[192:193], v15 offset:0
    ds_read_b64_tr_b16 v[194:195], v15 offset:1024
    ds_read_b64_tr_b16 v[196:197], v15 offset:8192
    ds_read_b64_tr_b16 v[198:199], v15 offset:9216
    v_xor_b32 v15, 160, v13
    ds_read_b64_tr_b16 v[200:201], v15 offset:0
    ds_read_b64_tr_b16 v[202:203], v15 offset:1024
    ds_read_b64_tr_b16 v[204:205], v15 offset:8192
    ds_read_b64_tr_b16 v[206:207], v15 offset:9216
    v_xor_b32 v15, 192, v13
    ds_read_b64_tr_b16 v[208:209], v15 offset:0
    ds_read_b64_tr_b16 v[210:211], v15 offset:1024
    ds_read_b64_tr_b16 v[212:213], v15 offset:8192
    ds_read_b64_tr_b16 v[214:215], v15 offset:9216
    v_xor_b32 v15, 224, v13
    ds_read_b64_tr_b16 v[216:217], v15 offset:0
    ds_read_b64_tr_b16 v[218:219], v15 offset:1024
    ds_read_b64_tr_b16 v[220:221], v15 offset:8192
    ds_read_b64_tr_b16 v[222:223], v15 offset:9216
    s_waitcnt lgkmcnt(15)
    ds_write_b128 v16, v[160:163]
    ds_write_b128 v20, v[164:167]
    ds_read_b128 v[160:163], v17 offset:0
    ds_read_b128 v[164:167], v17 offset:1024
    ds_write_b128 v16, v[168:171]
    ds_write_b128 v20, v[172:175]
    ds_read_b128 v[168:171], v17 offset:0
    ds_read_b128 v[172:175], v17 offset:1024
    s_waitcnt lgkmcnt(5)
    s_add_u32 s81, s83, 0
    buffer_store_dwordx4 v[160:163], v18, s[60:63], s81 offen sc1
    s_waitcnt lgkmcnt(4)
    s_add_u32 s81, s83, 32768
    buffer_store_dwordx4 v[164:167], v18, s[60:63], s81 offen sc1
    ds_write_b128 v16, v[176:179]
    ds_write_b128 v20, v[180:183]
    ds_read_b128 v[176:179], v17 offset:0
    ds_read_b128 v[180:183], v17 offset:1024
    s_waitcnt lgkmcnt(5)
    s_add_u32 s81, s83, 65536
    buffer_store_dwordx4 v[168:171], v18, s[60:63], s81 offen sc1
    s_waitcnt lgkmcnt(4)
    s_add_u32 s81, s83, 98304
    buffer_store_dwordx4 v[172:175], v18, s[60:63], s81 offen sc1
    ds_write_b128 v16, v[184:187]
    ds_write_b128 v20, v[188:191]
    ds_read_b128 v[184:187], v17 offset:0
    ds_read_b128 v[188:191], v17 offset:1024
    s_waitcnt lgkmcnt(5)
    s_add_u32 s81, s83, 131072
    buffer_store_dwordx4 v[176:179], v18, s[60:63], s81 offen sc1
    s_waitcnt lgkmcnt(4)
    s_add_u32 s81, s83, 163840
    buffer_store_dwordx4 v[180:183], v18, s[60:63], s81 offen sc1
    ds_write_b128 v16, v[192:195]
    ds_write_b128 v20, v[196:199]
    ds_read_b128 v[192:195], v17 offset:0
    ds_read_b128 v[196:199], v17 offset:1024
    s_waitcnt lgkmcnt(5)
    s_add_u32 s81, s83, 196608
    buffer_store_dwordx4 v[184:187], v18, s[60:63], s81 offen sc1
    s_waitcnt lgkmcnt(4)
    s_add_u32 s81, s83, 229376
    buffer_store_dwordx4 v[188:191], v18, s[60:63], s81 offen sc1
    ds_write_b128 v16, v[200:203]
    ds_write_b128 v20, v[204:207]
    ds_read_b128 v[200:203], v17 offset:0
    ds_read_b128 v[204:207], v17 offset:1024
    s_waitcnt lgkmcnt(5)
    s_add_u32 s81, s83, 262144
    buffer_store_dwordx4 v[192:195], v18, s[60:63], s81 offen sc1
    s_waitcnt lgkmcnt(4)
    s_add_u32 s81, s83, 294912
    buffer_store_dwordx4 v[196:199], v18, s[60:63], s81 offen sc1
    ds_write_b128 v16, v[208:211]
    ds_write_b128 v20, v[212:215]
    ds_read_b128 v[208:211], v17 offset:0
    ds_read_b128 v[212:215], v17 offset:1024
    s_waitcnt lgkmcnt(5)
    s_add_u32 s81, s83, 327680
    buffer_store_dwordx4 v[200:203], v18, s[60:63], s81 offen sc1
    s_waitcnt lgkmcnt(4)
    s_add_u32 s81, s83, 360448
    buffer_store_dwordx4 v[204:207], v18, s[60:63], s81 offen sc1
    ds_write_b128 v16, v[216:219]
    ds_write_b128 v20, v[220:223]
    ds_read_b128 v[216:219], v17 offset:0
    ds_read_b128 v[220:223], v17 offset:1024
    s_waitcnt lgkmcnt(5)
    s_add_u32 s81, s83, 393216
    buffer_store_dwordx4 v[208:211], v18, s[60:63], s81 offen sc1
    s_waitcnt lgkmcnt(4)
    s_add_u32 s81, s83, 425984
    buffer_store_dwordx4 v[212:215], v18, s[60:63], s81 offen sc1
    s_waitcnt lgkmcnt(1)
    s_add_u32 s81, s83, 458752
    buffer_store_dwordx4 v[216:219], v18, s[60:63], s81 offen sc1
    s_waitcnt lgkmcnt(0)
    s_add_u32 s81, s83, 491520
    buffer_store_dwordx4 v[220:223], v18, s[60:63], s81 offen sc1
    s_waitcnt vmcnt(16)
    v_readfirstlane_b32 s46, v26
    s_cmp_lg_u32 s46, 0
    s_cbranch_scc0 L_cold_44
L_back_45:
    s_lshl_b32 s79, s45, 5
    s_add_u32 s79, s79, s76
    s_lshl_b32 s79, s79, 7
    s_add_u32 s79, s79, 12910592
    s_waitcnt vmcnt(0)
    v_mov_b32 v26, s46
    v_lshlrev_b32 v27, 2, v1
    s_mov_b32 exec_hi, 0
    buffer_store_dword v26, v27, s[60:63], s79 offen sc1
    s_mov_b32 exec_hi, -1
    global_load_dwordx4 v[96:99], v12, s[30:31] offset:0
    global_load_dwordx4 v[100:103], v12, s[30:31] offset:64
    global_load_dwordx4 v[104:107], v12, s[30:31] offset:128
    global_load_dwordx4 v[108:111], v12, s[30:31] offset:192
    global_load_dwordx4 v[112:115], v12, s[30:31] offset:256
    global_load_dwordx4 v[116:119], v12, s[30:31] offset:320
    global_load_dwordx4 v[120:123], v12, s[30:31] offset:384
    global_load_dwordx4 v[124:127], v12, s[30:31] offset:448
    global_load_dwordx4 v[128:131], v12, s[30:31] offset:512
    global_load_dwordx4 v[132:135], v12, s[30:31] offset:576
    global_load_dwordx4 v[136:139], v12, s[30:31] offset:640
    global_load_dwordx4 v[140:143], v12, s[30:31] offset:704
    global_load_dwordx4 v[144:147], v12, s[30:31] offset:768
    global_load_dwordx4 v[148:151], v12, s[30:31] offset:832
    global_load_dwordx4 v[152:155], v12, s[30:31] offset:896
    global_load_dwordx4 v[156:159], v12, s[30:31] offset:960
    s_barrier
    s_lshl_b32 s79, s45, 12
    s_add_u32 s79, s79, 65536
    v_lshlrev_b32 v16, 8, v25
    v_add_u32 v16, s79, v16
    v_and_b32 v23, 3, v25
    v_bfe_u32 v24, v25, 3, 1
    v_lshl_add_u32 v23, v24, 2, v23
    v_lshrrev_b32 v24, 1, v22
    v_xor_b32 v23, v23, v24
    v_lshl_add_u32 v16, v23, 5, v16
    v_and_b32 v24, 1, v22
    v_lshl_add_u32 v16, v24, 4, v16
    v_xor_b32 v17, 0, v16
    ds_read_b128 v[32:35], v17 offset:0
    ds_read_b128 v[48:51], v17 offset:16384
    ds_read_b128 v[64:67], v17 offset:32768
    ds_read_b128 v[80:83], v17 offset:49152
    v_xor_b32 v17, 64, v16
    ds_read_b128 v[36:39], v17 offset:0
    ds_read_b128 v[52:55], v17 offset:16384
    ds_read_b128 v[68:71], v17 offset:32768
    ds_read_b128 v[84:87], v17 offset:49152
    v_xor_b32 v17, 128, v16
    ds_read_b128 v[40:43], v17 offset:0
    ds_read_b128 v[56:59], v17 offset:16384
    ds_read_b128 v[72:75], v17 offset:32768
    ds_read_b128 v[88:91], v17 offset:49152
    v_xor_b32 v17, 192, v16
    ds_read_b128 v[44:47], v17 offset:0
    ds_read_b128 v[60:63], v17 offset:16384
    ds_read_b128 v[76:79], v17 offset:32768
    ds_read_b128 v[92:95], v17 offset:49152
    v_mov_b32 v28, 0x3f803f80
    v_mov_b32 v29, 0x3f803f80
    v_mov_b32 v30, 0x3f803f80
    v_mov_b32 v31, 0x3f803f80
    s_waitcnt lgkmcnt(0)
    s_waitcnt vmcnt(0)
    v_lshlrev_b32 v160, 16, v32
    v_and_b32 v161, 0xffff0000, v32
    v_lshlrev_b32 v162, 16, v96
    v_and_b32 v163, 0xffff0000, v96
    v_lshlrev_b32 v164, 16, v33
    v_and_b32 v165, 0xffff0000, v33
    v_lshlrev_b32 v166, 16, v97
    v_and_b32 v167, 0xffff0000, v97
    v_lshlrev_b32 v168, 16, v34
    v_and_b32 v169, 0xffff0000, v34
    v_lshlrev_b32 v170, 16, v98
    v_and_b32 v171, 0xffff0000, v98
    v_lshlrev_b32 v172, 16, v35
    v_and_b32 v173, 0xffff0000, v35
    v_lshlrev_b32 v174, 16, v99
    v_and_b32 v175, 0xffff0000, v99
    v_pk_mul_f32 v[160:161], v[160:161], v[162:163]
    v_pk_mul_f32 v[164:165], v[164:165], v[166:167]
    v_pk_mul_f32 v[168:169], v[168:169], v[170:171]
    v_pk_mul_f32 v[172:173], v[172:173], v[174:175]
    v_cvt_pk_bf16_f32 v32, v160, v161
    v_cvt_pk_bf16_f32 v33, v164, v165
    v_cvt_pk_bf16_f32 v34, v168, v169
    v_cvt_pk_bf16_f32 v35, v172, v173
    s_nop 1
    v_mfma_f32_16x16x32_bf16 v[224:227], v[28:31], v[32:35], 0
    v_lshlrev_b32 v160, 16, v36
    v_and_b32 v161, 0xffff0000, v36
    v_lshlrev_b32 v162, 16, v100
    v_and_b32 v163, 0xffff0000, v100
    v_lshlrev_b32 v164, 16, v37
    v_and_b32 v165, 0xffff0000, v37
    v_lshlrev_b32 v166, 16, v101
    v_and_b32 v167, 0xffff0000, v101
    v_lshlrev_b32 v168, 16, v38
    v_and_b32 v169, 0xffff0000, v38
    v_lshlrev_b32 v170, 16, v102
    v_and_b32 v171, 0xffff0000, v102
    v_lshlrev_b32 v172, 16, v39
    v_and_b32 v173, 0xffff0000, v39
    v_lshlrev_b32 v174, 16, v103
    v_and_b32 v175, 0xffff0000, v103
    v_pk_mul_f32 v[160:161], v[160:161], v[162:163]
    v_pk_mul_f32 v[164:165], v[164:165], v[166:167]
    v_pk_mul_f32 v[168:169], v[168:169], v[170:171]
    v_pk_mul_f32 v[172:173], v[172:173], v[174:175]
    v_cvt_pk_bf16_f32 v36, v160, v161
    v_cvt_pk_bf16_f32 v37, v164, v165
    v_cvt_pk_bf16_f32 v38, v168, v169
    v_cvt_pk_bf16_f32 v39, v172, v173
    s_nop 1
    v_mfma_f32_16x16x32_bf16 v[224:227], v[28:31], v[36:39], v[224:227]
    v_lshlrev_b32 v160, 16, v40
    v_and_b32 v161, 0xffff0000, v40
    v_lshlrev_b32 v162, 16, v104
    v_and_b32 v163, 0xffff0000, v104
    v_lshlrev_b32 v164, 16, v41
    v_and_b32 v165, 0xffff0000, v41
    v_lshlrev_b32 v166, 16, v105
    v_and_b32 v167, 0xffff0000, v105
    v_lshlrev_b32 v168, 16, v42
    v_and_b32 v169, 0xffff0000, v42
    v_lshlrev_b32 v170, 16, v106
    v_and_b32 v171, 0xffff0000, v106
    v_lshlrev_b32 v172, 16, v43
    v_and_b32 v173, 0xffff0000, v43
    v_lshlrev_b32 v174, 16, v107
    v_and_b32 v175, 0xffff0000, v107
    v_pk_mul_f32 v[160:161], v[160:161], v[162:163]
    v_pk_mul_f32 v[164:165], v[164:165], v[166:167]
    v_pk_mul_f32 v[168:169], v[168:169], v[170:171]
    v_pk_mul_f32 v[172:173], v[172:173], v[174:175]
    v_cvt_pk_bf16_f32 v40, v160, v161
    v_cvt_pk_bf16_f32 v41, v164, v165
    v_cvt_pk_bf16_f32 v42, v168, v169
    v_cvt_pk_bf16_f32 v43, v172, v173
    s_nop 1
    v_mfma_f32_16x16x32_bf16 v[224:227], v[28:31], v[40:43], v[224:227]
    v_lshlrev_b32 v160, 16, v44
    v_and_b32 v161, 0xffff0000, v44
    v_lshlrev_b32 v162, 16, v108
    v_and_b32 v163, 0xffff0000, v108
    v_lshlrev_b32 v164, 16, v45
    v_and_b32 v165, 0xffff0000, v45
    v_lshlrev_b32 v166, 16, v109
    v_and_b32 v167, 0xffff0000, v109
    v_lshlrev_b32 v168, 16, v46
    v_and_b32 v169, 0xffff0000, v46
    v_lshlrev_b32 v170, 16, v110
    v_and_b32 v171, 0xffff0000, v110
    v_lshlrev_b32 v172, 16, v47
    v_and_b32 v173, 0xffff0000, v47
    v_lshlrev_b32 v174, 16, v111
    v_and_b32 v175, 0xffff0000, v111
    v_pk_mul_f32 v[160:161], v[160:161], v[162:163]
    v_pk_mul_f32 v[164:165], v[164:165], v[166:167]
    v_pk_mul_f32 v[168:169], v[168:169], v[170:171]
    v_pk_mul_f32 v[172:173], v[172:173], v[174:175]
    v_cvt_pk_bf16_f32 v44, v160, v161
    v_cvt_pk_bf16_f32 v45, v164, v165
    v_cvt_pk_bf16_f32 v46, v168, v169
    v_cvt_pk_bf16_f32 v47, v172, v173
    s_nop 1
    v_mfma_f32_16x16x32_bf16 v[224:227], v[28:31], v[44:47], v[224:227]
    v_lshlrev_b32 v160, 16, v48
    v_and_b32 v161, 0xffff0000, v48
    v_lshlrev_b32 v162, 16, v112
    v_and_b32 v163, 0xffff0000, v112
    v_lshlrev_b32 v164, 16, v49
    v_and_b32 v165, 0xffff0000, v49
    v_lshlrev_b32 v166, 16, v113
    v_and_b32 v167, 0xffff0000, v113
    v_lshlrev_b32 v168, 16, v50
    v_and_b32 v169, 0xffff0000, v50
    v_lshlrev_b32 v170, 16, v114
    v_and_b32 v171, 0xffff0000, v114
    v_lshlrev_b32 v172, 16, v51
    v_and_b32 v173, 0xffff0000, v51
    v_lshlrev_b32 v174, 16, v115
    v_and_b32 v175, 0xffff0000, v115
    v_pk_mul_f32 v[160:161], v[160:161], v[162:163]
    v_pk_mul_f32 v[164:165], v[164:165], v[166:167]
    v_pk_mul_f32 v[168:169], v[168:169], v[170:171]
    v_pk_mul_f32 v[172:173], v[172:173], v[174:175]
    v_cvt_pk_bf16_f32 v48, v160, v161
    v_cvt_pk_bf16_f32 v49, v164, v165
    v_cvt_pk_bf16_f32 v50, v168, v169
    v_cvt_pk_bf16_f32 v51, v172, v173
    s_nop 1
    v_mfma_f32_16x16x32_bf16 v[224:227], v[28:31], v[48:51], v[224:227]
    v_lshlrev_b32 v160, 16, v52
    v_and_b32 v161, 0xffff0000, v52
    v_lshlrev_b32 v162, 16, v116
    v_and_b32 v163, 0xffff0000, v116
    v_lshlrev_b32 v164, 16, v53
    v_and_b32 v165, 0xffff0000, v53
    v_lshlrev_b32 v166, 16, v117
    v_and_b32 v167, 0xffff0000, v117
    v_lshlrev_b32 v168, 16, v54
    v_and_b32 v169, 0xffff0000, v54
    v_lshlrev_b32 v170, 16, v118
    v_and_b32 v171, 0xffff0000, v118
    v_lshlrev_b32 v172, 16, v55
    v_and_b32 v173, 0xffff0000, v55
    v_lshlrev_b32 v174, 16, v119
    v_and_b32 v175, 0xffff0000, v119
    v_pk_mul_f32 v[160:161], v[160:161], v[162:163]
    v_pk_mul_f32 v[164:165], v[164:165], v[166:167]
    v_pk_mul_f32 v[168:169], v[168:169], v[170:171]
    v_pk_mul_f32 v[172:173], v[172:173], v[174:175]
    v_cvt_pk_bf16_f32 v52, v160, v161
    v_cvt_pk_bf16_f32 v53, v164, v165
    v_cvt_pk_bf16_f32 v54, v168, v169
    v_cvt_pk_bf16_f32 v55, v172, v173
    s_nop 1
    v_mfma_f32_16x16x32_bf16 v[224:227], v[28:31], v[52:55], v[224:227]
    v_lshlrev_b32 v160, 16, v56
    v_and_b32 v161, 0xffff0000, v56
    v_lshlrev_b32 v162, 16, v120
    v_and_b32 v163, 0xffff0000, v120
    v_lshlrev_b32 v164, 16, v57
    v_and_b32 v165, 0xffff0000, v57
    v_lshlrev_b32 v166, 16, v121
    v_and_b32 v167, 0xffff0000, v121
    v_lshlrev_b32 v168, 16, v58
    v_and_b32 v169, 0xffff0000, v58
    v_lshlrev_b32 v170, 16, v122
    v_and_b32 v171, 0xffff0000, v122
    v_lshlrev_b32 v172, 16, v59
    v_and_b32 v173, 0xffff0000, v59
    v_lshlrev_b32 v174, 16, v123
    v_and_b32 v175, 0xffff0000, v123
    v_pk_mul_f32 v[160:161], v[160:161], v[162:163]
    v_pk_mul_f32 v[164:165], v[164:165], v[166:167]
    v_pk_mul_f32 v[168:169], v[168:169], v[170:171]
    v_pk_mul_f32 v[172:173], v[172:173], v[174:175]
    v_cvt_pk_bf16_f32 v56, v160, v161
    v_cvt_pk_bf16_f32 v57, v164, v165
    v_cvt_pk_bf16_f32 v58, v168, v169
    v_cvt_pk_bf16_f32 v59, v172, v173
    s_nop 1
    v_mfma_f32_16x16x32_bf16 v[224:227], v[28:31], v[56:59], v[224:227]
    v_lshlrev_b32 v160, 16, v60
    v_and_b32 v161, 0xffff0000, v60
    v_lshlrev_b32 v162, 16, v124
    v_and_b32 v163, 0xffff0000, v124
    v_lshlrev_b32 v164, 16, v61
    v_and_b32 v165, 0xffff0000, v61
    v_lshlrev_b32 v166, 16, v125
    v_and_b32 v167, 0xffff0000, v125
    v_lshlrev_b32 v168, 16, v62
    v_and_b32 v169, 0xffff0000, v62
    v_lshlrev_b32 v170, 16, v126
    v_and_b32 v171, 0xffff0000, v126
    v_lshlrev_b32 v172, 16, v63
    v_and_b32 v173, 0xffff0000, v63
    v_lshlrev_b32 v174, 16, v127
    v_and_b32 v175, 0xffff0000, v127
    v_pk_mul_f32 v[160:161], v[160:161], v[162:163]
    v_pk_mul_f32 v[164:165], v[164:165], v[166:167]
    v_pk_mul_f32 v[168:169], v[168:169], v[170:171]
    v_pk_mul_f32 v[172:173], v[172:173], v[174:175]
    v_cvt_pk_bf16_f32 v60, v160, v161
    v_cvt_pk_bf16_f32 v61, v164, v165
    v_cvt_pk_bf16_f32 v62, v168, v169
    v_cvt_pk_bf16_f32 v63, v172, v173
    s_nop 1
    v_mfma_f32_16x16x32_bf16 v[224:227], v[28:31], v[60:63], v[224:227]
    v_lshlrev_b32 v160, 16, v64
    v_and_b32 v161, 0xffff0000, v64
    v_lshlrev_b32 v162, 16, v128
    v_and_b32 v163, 0xffff0000, v128
    v_lshlrev_b32 v164, 16, v65
    v_and_b32 v165, 0xffff0000, v65
    v_lshlrev_b32 v166, 16, v129
    v_and_b32 v167, 0xffff0000, v129
    v_lshlrev_b32 v168, 16, v66
    v_and_b32 v169, 0xffff0000, v66
    v_lshlrev_b32 v170, 16, v130
    v_and_b32 v171, 0xffff0000, v130
    v_lshlrev_b32 v172, 16, v67
    v_and_b32 v173, 0xffff0000, v67
    v_lshlrev_b32 v174, 16, v131
    v_and_b32 v175, 0xffff0000, v131
    v_pk_mul_f32 v[160:161], v[160:161], v[162:163]
    v_pk_mul_f32 v[164:165], v[164:165], v[166:167]
    v_pk_mul_f32 v[168:169], v[168:169], v[170:171]
    v_pk_mul_f32 v[172:173], v[172:173], v[174:175]
    v_cvt_pk_bf16_f32 v64, v160, v161
    v_cvt_pk_bf16_f32 v65, v164, v165
    v_cvt_pk_bf16_f32 v66, v168, v169
    v_cvt_pk_bf16_f32 v67, v172, v173
    s_nop 1
    v_mfma_f32_16x16x32_bf16 v[224:227], v[28:31], v[64:67], v[224:227]
    v_lshlrev_b32 v160, 16, v68
    v_and_b32 v161, 0xffff0000, v68
    v_lshlrev_b32 v162, 16, v132
    v_and_b32 v163, 0xffff0000, v132
    v_lshlrev_b32 v164, 16, v69
    v_and_b32 v165, 0xffff0000, v69
    v_lshlrev_b32 v166, 16, v133
    v_and_b32 v167, 0xffff0000, v133
    v_lshlrev_b32 v168, 16, v70
    v_and_b32 v169, 0xffff0000, v70
    v_lshlrev_b32 v170, 16, v134
    v_and_b32 v171, 0xffff0000, v134
    v_lshlrev_b32 v172, 16, v71
    v_and_b32 v173, 0xffff0000, v71
    v_lshlrev_b32 v174, 16, v135
    v_and_b32 v175, 0xffff0000, v135
    v_pk_mul_f32 v[160:161], v[160:161], v[162:163]
    v_pk_mul_f32 v[164:165], v[164:165], v[166:167]
    v_pk_mul_f32 v[168:169], v[168:169], v[170:171]
    v_pk_mul_f32 v[172:173], v[172:173], v[174:175]
    v_cvt_pk_bf16_f32 v68, v160, v161
    v_cvt_pk_bf16_f32 v69, v164, v165
    v_cvt_pk_bf16_f32 v70, v168, v169
    v_cvt_pk_bf16_f32 v71, v172, v173
    s_nop 1
    v_mfma_f32_16x16x32_bf16 v[224:227], v[28:31], v[68:71], v[224:227]
    v_lshlrev_b32 v160, 16, v72
    v_and_b32 v161, 0xffff0000, v72
    v_lshlrev_b32 v162, 16, v136
    v_and_b32 v163, 0xffff0000, v136
    v_lshlrev_b32 v164, 16, v73
    v_and_b32 v165, 0xffff0000, v73
    v_lshlrev_b32 v166, 16, v137
    v_and_b32 v167, 0xffff0000, v137
    v_lshlrev_b32 v168, 16, v74
    v_and_b32 v169, 0xffff0000, v74
    v_lshlrev_b32 v170, 16, v138
    v_and_b32 v171, 0xffff0000, v138
    v_lshlrev_b32 v172, 16, v75
    v_and_b32 v173, 0xffff0000, v75
    v_lshlrev_b32 v174, 16, v139
    v_and_b32 v175, 0xffff0000, v139
    v_pk_mul_f32 v[160:161], v[160:161], v[162:163]
    v_pk_mul_f32 v[164:165], v[164:165], v[166:167]
    v_pk_mul_f32 v[168:169], v[168:169], v[170:171]
    v_pk_mul_f32 v[172:173], v[172:173], v[174:175]
    v_cvt_pk_bf16_f32 v72, v160, v161
    v_cvt_pk_bf16_f32 v73, v164, v165
    v_cvt_pk_bf16_f32 v74, v168, v169
    v_cvt_pk_bf16_f32 v75, v172, v173
    s_nop 1
    v_mfma_f32_16x16x32_bf16 v[224:227], v[28:31], v[72:75], v[224:227]
    v_lshlrev_b32 v160, 16, v76
    v_and_b32 v161, 0xffff0000, v76
    v_lshlrev_b32 v162, 16, v140
    v_and_b32 v163, 0xffff0000, v140
    v_lshlrev_b32 v164, 16, v77
    v_and_b32 v165, 0xffff0000, v77
    v_lshlrev_b32 v166, 16, v141
    v_and_b32 v167, 0xffff0000, v141
    v_lshlrev_b32 v168, 16, v78
    v_and_b32 v169, 0xffff0000, v78
    v_lshlrev_b32 v170, 16, v142
    v_and_b32 v171, 0xffff0000, v142
    v_lshlrev_b32 v172, 16, v79
    v_and_b32 v173, 0xffff0000, v79
    v_lshlrev_b32 v174, 16, v143
    v_and_b32 v175, 0xffff0000, v143
    v_pk_mul_f32 v[160:161], v[160:161], v[162:163]
    v_pk_mul_f32 v[164:165], v[164:165], v[166:167]
    v_pk_mul_f32 v[168:169], v[168:169], v[170:171]
    v_pk_mul_f32 v[172:173], v[172:173], v[174:175]
    v_cvt_pk_bf16_f32 v76, v160, v161
    v_cvt_pk_bf16_f32 v77, v164, v165
    v_cvt_pk_bf16_f32 v78, v168, v169
    v_cvt_pk_bf16_f32 v79, v172, v173
    s_nop 1
    v_mfma_f32_16x16x32_bf16 v[224:227], v[28:31], v[76:79], v[224:227]
    v_lshlrev_b32 v160, 16, v80
    v_and_b32 v161, 0xffff0000, v80
    v_lshlrev_b32 v162, 16, v144
    v_and_b32 v163, 0xffff0000, v144
    v_lshlrev_b32 v164, 16, v81
    v_and_b32 v165, 0xffff0000, v81
    v_lshlrev_b32 v166, 16, v145
    v_and_b32 v167, 0xffff0000, v145
    v_lshlrev_b32 v168, 16, v82
    v_and_b32 v169, 0xffff0000, v82
    v_lshlrev_b32 v170, 16, v146
    v_and_b32 v171, 0xffff0000, v146
    v_lshlrev_b32 v172, 16, v83
    v_and_b32 v173, 0xffff0000, v83
    v_lshlrev_b32 v174, 16, v147
    v_and_b32 v175, 0xffff0000, v147
    v_pk_mul_f32 v[160:161], v[160:161], v[162:163]
    v_pk_mul_f32 v[164:165], v[164:165], v[166:167]
    v_pk_mul_f32 v[168:169], v[168:169], v[170:171]
    v_pk_mul_f32 v[172:173], v[172:173], v[174:175]
    v_cvt_pk_bf16_f32 v80, v160, v161
    v_cvt_pk_bf16_f32 v81, v164, v165
    v_cvt_pk_bf16_f32 v82, v168, v169
    v_cvt_pk_bf16_f32 v83, v172, v173
    s_nop 1
    v_mfma_f32_16x16x32_bf16 v[224:227], v[28:31], v[80:83], v[224:227]
    v_lshlrev_b32 v160, 16, v84
    v_and_b32 v161, 0xffff0000, v84
    v_lshlrev_b32 v162, 16, v148
    v_and_b32 v163, 0xffff0000, v148
    v_lshlrev_b32 v164, 16, v85
    v_and_b32 v165, 0xffff0000, v85
    v_lshlrev_b32 v166, 16, v149
    v_and_b32 v167, 0xffff0000, v149
    v_lshlrev_b32 v168, 16, v86
    v_and_b32 v169, 0xffff0000, v86
    v_lshlrev_b32 v170, 16, v150
    v_and_b32 v171, 0xffff0000, v150
    v_lshlrev_b32 v172, 16, v87
    v_and_b32 v173, 0xffff0000, v87
    v_lshlrev_b32 v174, 16, v151
    v_and_b32 v175, 0xffff0000, v151
    v_pk_mul_f32 v[160:161], v[160:161], v[162:163]
    v_pk_mul_f32 v[164:165], v[164:165], v[166:167]
    v_pk_mul_f32 v[168:169], v[168:169], v[170:171]
    v_pk_mul_f32 v[172:173], v[172:173], v[174:175]
    v_cvt_pk_bf16_f32 v84, v160, v161
    v_cvt_pk_bf16_f32 v85, v164, v165
    v_cvt_pk_bf16_f32 v86, v168, v169
    v_cvt_pk_bf16_f32 v87, v172, v173
    s_nop 1
    v_mfma_f32_16x16x32_bf16 v[224:227], v[28:31], v[84:87], v[224:227]
    v_lshlrev_b32 v160, 16, v88
    v_and_b32 v161, 0xffff0000, v88
    v_lshlrev_b32 v162, 16, v152
    v_and_b32 v163, 0xffff0000, v152
    v_lshlrev_b32 v164, 16, v89
    v_and_b32 v165, 0xffff0000, v89
    v_lshlrev_b32 v166, 16, v153
    v_and_b32 v167, 0xffff0000, v153
    v_lshlrev_b32 v168, 16, v90
    v_and_b32 v169, 0xffff0000, v90
    v_lshlrev_b32 v170, 16, v154
    v_and_b32 v171, 0xffff0000, v154
    v_lshlrev_b32 v172, 16, v91
    v_and_b32 v173, 0xffff0000, v91
    v_lshlrev_b32 v174, 16, v155
    v_and_b32 v175, 0xffff0000, v155
    v_pk_mul_f32 v[160:161], v[160:161], v[162:163]
    v_pk_mul_f32 v[164:165], v[164:165], v[166:167]
    v_pk_mul_f32 v[168:169], v[168:169], v[170:171]
    v_pk_mul_f32 v[172:173], v[172:173], v[174:175]
    v_cvt_pk_bf16_f32 v88, v160, v161
    v_cvt_pk_bf16_f32 v89, v164, v165
    v_cvt_pk_bf16_f32 v90, v168, v169
    v_cvt_pk_bf16_f32 v91, v172, v173
    s_nop 1
    v_mfma_f32_16x16x32_bf16 v[224:227], v[28:31], v[88:91], v[224:227]
    v_lshlrev_b32 v160, 16, v92
    v_and_b32 v161, 0xffff0000, v92
    v_lshlrev_b32 v162, 16, v156
    v_and_b32 v163, 0xffff0000, v156
    v_lshlrev_b32 v164, 16, v93
    v_and_b32 v165, 0xffff0000, v93
    v_lshlrev_b32 v166, 16, v157
    v_and_b32 v167, 0xffff0000, v157
    v_lshlrev_b32 v168, 16, v94
    v_and_b32 v169, 0xffff0000, v94
    v_lshlrev_b32 v170, 16, v158
    v_and_b32 v171, 0xffff0000, v158
    v_lshlrev_b32 v172, 16, v95
    v_and_b32 v173, 0xffff0000, v95
    v_lshlrev_b32 v174, 16, v159
    v_and_b32 v175, 0xffff0000, v159
    v_pk_mul_f32 v[160:161], v[160:161], v[162:163]
    v_pk_mul_f32 v[164:165], v[164:165], v[166:167]
    v_pk_mul_f32 v[168:169], v[168:169], v[170:171]
    v_pk_mul_f32 v[172:173], v[172:173], v[174:175]
    v_cvt_pk_bf16_f32 v92, v160, v161
    v_cvt_pk_bf16_f32 v93, v164, v165
    v_cvt_pk_bf16_f32 v94, v168, v169
    v_cvt_pk_bf16_f32 v95, v172, v173
    s_nop 1
    v_mfma_f32_16x16x32_bf16 v[224:227], v[28:31], v[92:95], v[224:227]
    s_nop 9
    v_cvt_pk_bf16_f32 v224, v224, v224
    v_and_b32 v224, 0xffff0000, v224
    v_mul_f32 v225, 0x3fb8aa3b, v224
    v_exp_f32 v225, -v225
    s_nop 0
    v_add_f32 v225, 1.0, v225
    v_rcp_f32 v225, v225
    s_nop 0
    v_cvt_pk_bf16_f32 v225, v225, v225
    v_and_b32 v225, 0xffff0000, v225
    s_lshl_b32 s79, s76, 8
    s_lshl_b32 s81, s45, 6
    s_add_u32 s79, s79, s81
    s_add_u32 s79, s79, 12582912
    v_lshlrev_b32 v226, 2, v25
    buffer_store_dword v225, v226, s[60:63], s79 offen sc1
    s_lshl_b32 s78, s76, 2
    s_add_u32 s78, s78, s45
    s_lshl_b32 s78, s78, 7
    s_add_u32 s78, s78, 12926976
    s_waitcnt vmcnt(0)
    v_mov_b32 v22, s46
    v_lshlrev_b32 v23, 2, v1
    s_mov_b32 exec_hi, 0
    buffer_store_dword v22, v23, s[60:63], s78 offen sc1
    s_mov_b32 exec_hi, -1
    v_and_b32 v13, 3, v1
    v_lshlrev_b32 v13, 7, v13
    s_lshl_b32 s78, s76, 9
    s_add_u32 s78, s78, 12926976
    s_mov_b32 s47, 0
L_poll_47:
    buffer_load_dword v12, v13, s[60:63], s78 offen sc1
    s_waitcnt vmcnt(0)
    v_cmp_ne_u32 vcc, s46, v12
    s_cmp_eq_u64 vcc, 0
    s_cselect_b32 s47, 40000, s47
    s_add_u32 s47, s47, 1
    s_cmp_lt_u32 s47, 40000
    s_cbranch_scc1 L_poll_47
    s_add_u32 m0, s66, 0
    s_mov_b32 s67, 0
    buffer_load_dwordx4 v2, s[52:55], s67 offen lds
    s_add_u32 m0, s66, 1024
    s_mov_b32 s67, 8192
    buffer_load_dwordx4 v2, s[52:55], s67 offen lds
    s_add_u32 m0, s66, 2048
    s_mov_b32 s67, 16384
    buffer_load_dwordx4 v2, s[52:55], s67 offen lds
    s_add_u32 m0, s66, 3072
    s_mov_b32 s67, 24576
    buffer_load_dwordx4 v2, s[52:55], s67 offen lds
    s_add_u32 m0, s66, 4096
    s_mov_b32 s67, 32768
    buffer_load_dwordx4 v2, s[52:55], s67 offen lds
    s_add_u32 m0, s66, 5120
    s_mov_b32 s67, 40960
    buffer_load_dwordx4 v2, s[52:55], s67 offen lds
    s_add_u32 m0, s66, 24576
    s_mov_b32 s67, 49152
    buffer_load_dwordx4 v2, s[52:55], s67 offen lds
    s_add_u32 m0, s66, 25600
    s_mov_b32 s67, 57344
    buffer_load_dwordx4 v2, s[52:55], s67 offen lds
    s_add_u32 m0, s66, 26624
    s_mov_b32 s67, 65536
    buffer_load_dwordx4 v2, s[52:55], s67 offen lds
    s_add_u32 m0, s66, 27648
    s_mov_b32 s67, 73728
    buffer_load_dwordx4 v2, s[52:55], s67 offen lds
    s_add_u32 m0, s66, 28672
    s_mov_b32 s67, 81920
    buffer_load_dwordx4 v2, s[52:55], s67 offen lds
    s_add_u32 m0, s66, 29696
    s_mov_b32 s67, 90112
    buffer_load_dwordx4 v2, s[52:55], s67 offen lds
    s_add_u32 m0, s66, 49152
    s_mov_b32 s67, 98304
    buffer_load_dwordx4 v2, s[52:55], s67 offen lds
    s_add_u32 m0, s66, 50176
    s_mov_b32 s67, 106496
    buffer_load_dwordx4 v2, s[52:55], s67 offen lds
    s_add_u32 m0, s66, 51200
    s_mov_b32 s67, 114688
    buffer_load_dwordx4 v2, s[52:55], s67 offen lds
    s_add_u32 m0, s66, 52224
    s_mov_b32 s67, 122880
    buffer_load_dwordx4 v2, s[52:55], s67 offen lds
    s_add_u32 m0, s66, 53248
    s_mov_b32 s67, 131072
    buffer_load_dwordx4 v2, s[52:55], s67 offen lds
    s_add_u32 m0, s66, 54272
    s_mov_b32 s67, 139264
    buffer_load_dwordx4 v2, s[52:55], s67 offen lds
    s_waitcnt vmcnt(0)
    s_branch L_G2
L_cold_3:
    s_mov_b32 s47, 0
L_gp_5:
    buffer_load_dword v10, v9, s[60:63], s82 offen sc1
    s_waitcnt vmcnt(0)
    v_cmp_eq_u32 vcc, s46, v10
    s_nop 0
    s_mov_b32 s83, vcc_lo
    s_bitcmp1_b32 s83, 0
    s_cselect_b32 s47, 40000, s47
    s_add_u32 s47, s47, 1
    s_cmp_lt_u32 s47, 40000
    s_cbranch_scc1 L_gp_5
    s_branch L_back_4
L_cold_6:
    s_mov_b32 s47, 0
L_gp_8:
    buffer_load_dword v10, v9, s[60:63], s82 offen sc1
    s_waitcnt vmcnt(0)
    v_cmp_eq_u32 vcc, s46, v10
    s_nop 0
    s_mov_b32 s83, vcc_lo
    s_bitcmp1_b32 s83, 1
    s_cselect_b32 s47, 40000, s47
    s_add_u32 s47, s47, 1
    s_cmp_lt_u32 s47, 40000
    s_cbranch_scc1 L_gp_8
    s_branch L_back_7
L_cold_9:
    s_mov_b32 s47, 0
L_gp_11:
    buffer_load_dword v10, v9, s[60:63], s82 offen sc1
    s_waitcnt vmcnt(0)
    v_cmp_eq_u32 vcc, s46, v10
    s_nop 0
    s_mov_b32 s83, vcc_lo
    s_bitcmp1_b32 s83, 2
    s_cselect_b32 s47, 40000, s47
    s_add_u32 s47, s47, 1
    s_cmp_lt_u32 s47, 40000
    s_cbranch_scc1 L_gp_11
    s_branch L_back_10
L_cold_12:
    s_mov_b32 s47, 0
L_gp_14:
    buffer_load_dword v10, v9, s[60:63], s82 offen sc1
    s_waitcnt vmcnt(0)
    v_cmp_eq_u32 vcc, s46, v10
    s_nop 0
    s_mov_b32 s83, vcc_lo
    s_bitcmp1_b32 s83, 3
    s_cselect_b32 s47, 40000, s47
    s_add_u32 s47, s47, 1
    s_cmp_lt_u32 s47, 40000
    s_cbranch_scc1 L_gp_14
    s_branch L_back_13
L_cold_15:
    s_mov_b32 s47, 0
L_gp_17:
    buffer_load_dword v10, v9, s[60:63], s82 offen sc1
    s_waitcnt vmcnt(0)
    v_cmp_eq_u32 vcc, s46, v10
    s_nop 0
    s_mov_b32 s83, vcc_lo
    s_bitcmp1_b32 s83, 4
    s_cselect_b32 s47, 40000, s47
    s_add_u32 s47, s47, 1
    s_cmp_lt_u32 s47, 40000
    s_cbranch_scc1 L_gp_17
    s_branch L_back_16
L_cold_18:
    s_mov_b32 s47, 0
L_gp_20:
    buffer_load_dword v10, v9, s[60:63], s82 offen sc1
    s_waitcnt vmcnt(0)
    v_cmp_eq_u32 vcc, s46, v10
    s_nop 0
    s_mov_b32 s83, vcc_lo
    s_bitcmp1_b32 s83, 5
    s_cselect_b32 s47, 40000, s47
    s_add_u32 s47, s47, 1
    s_cmp_lt_u32 s47, 40000
    s_cbranch_scc1 L_gp_20
    s_branch L_back_19
L_cold_21:
    s_mov_b32 s47, 0
L_gp_23:
    buffer_load_dword v10, v9, s[60:63], s82 offen sc1
    s_waitcnt vmcnt(0)
    v_cmp_eq_u32 vcc, s46, v10
    s_nop 0
    s_mov_b32 s83, vcc_lo
    s_bitcmp1_b32 s83, 6
    s_cselect_b32 s47, 40000, s47
    s_add_u32 s47, s47, 1
    s_cmp_lt_u32 s47, 40000
    s_cbranch_scc1 L_gp_23
    s_branch L_back_22
L_cold_24:
    s_mov_b32 s47, 0
L_poll_26:
    buffer_load_dword v13, v12, s[60:63], s76 offen sc1
    s_waitcnt vmcnt(0)
    v_cmp_ne_u32 vcc, s46, v13
    s_cmp_eq_u64 vcc, 0
    s_cselect_b32 s47, 40000, s47
    s_add_u32 s47, s47, 1
    s_cmp_lt_u32 s47, 40000
    s_cbranch_scc1 L_poll_26
    s_branch L_back_25
L_cold_27:
    v_mov_b32 v245, 0
    s_mov_b32 s47, 0
L_tag_29:
    global_load_dword v244, v245, s[34:35] sc1
    s_waitcnt vmcnt(0)
    v_readfirstlane_b32 s46, v244
    s_cmp_lg_u32 s46, 0
    s_cselect_b32 s47, 40000, s47
    s_add_u32 s47, s47, 1
    s_cmp_lt_u32 s47, 40000
    s_cbranch_scc1 L_tag_29
    s_branch L_back_28
L_cold_30:
    s_mov_b32 s47, 0
L_poll_32:
    buffer_load_dword v247, v246, s[60:63], s79 offen sc1
    s_waitcnt vmcnt(0)
    v_cmp_ne_u32 vcc, s46, v247
    s_cmp_eq_u64 vcc, 0
    s_cselect_b32 s47, 40000, s47
    s_add_u32 s47, s47, 1
    s_cmp_lt_u32 s47, 40000
    s_cbranch_scc1 L_poll_32
    s_branch L_back_31
L_cold_37:
    v_mov_b32 v245, 0
    s_mov_b32 s47, 0
L_tag_39:
    global_load_dword v244, v245, s[34:35] sc1
    s_waitcnt vmcnt(0)
    v_readfirstlane_b32 s46, v244
    s_cmp_lg_u32 s46, 0
    s_cselect_b32 s47, 40000, s47
    s_add_u32 s47, s47, 1
    s_cmp_lt_u32 s47, 40000
    s_cbranch_scc1 L_tag_39
    s_branch L_back_38
L_cold_40:
    s_mov_b32 s47, 0
L_poll_42:
    buffer_load_dword v247, v246, s[60:63], s79 offen sc1
    s_waitcnt vmcnt(0)
    v_cmp_ne_u32 vcc, s46, v247
    s_cmp_eq_u64 vcc, 0
    s_cselect_b32 s47, 40000, s47
    s_add_u32 s47, s47, 1
    s_cmp_lt_u32 s47, 40000
    s_cbranch_scc1 L_poll_42
    s_branch L_back_41
L_cold_44:
    v_mov_b32 v27, 0
    s_mov_b32 s47, 0
L_tag_46:
    global_load_dword v26, v27, s[34:35] sc1
    s_waitcnt vmcnt(0)
    v_readfirstlane_b32 s46, v26
    s_cmp_lg_u32 s46, 0
    s_cselect_b32 s47, 40000, s47
    s_add_u32 s47, s47, 1
    s_cmp_lt_u32 s47, 40000
    s_cbranch_scc1 L_tag_46
    s_branch L_back_45
L_end:
    s_endpgm
.section .rodata,"a"
.p2align 6
.amdhsa_kernel gated_mix__ssm_conv_s4__glu_gated_swiglu__prompt_kernel
  .amdhsa_next_free_vgpr 256
  .amdhsa_next_free_sgpr 102
  .amdhsa_accum_offset 256
  .amdhsa_group_segment_fixed_size 0
  .amdhsa_kernarg_size 136
  .amdhsa_user_sgpr_count 2
  .amdhsa_user_sgpr_kernarg_segment_ptr 1
  .amdhsa_system_sgpr_workgroup_id_x 1
.end_amdhsa_kernel
```
